```python
import torch

def _softmax(x, axis=-1):
    return torch.softmax(x, dim=axis)
def _gelu(x):
    return torch.nn.functional.gelu(x, approximate="tanh")
def _silu(x):
    return torch.nn.functional.silu(x)
def _sigmoid(x):
    return torch.sigmoid(x)
def _layernorm(x, axis=-1, eps=1e-5):
    m = x.mean(dim=axis, keepdim=True)
    v = x.var(dim=axis, keepdim=True, unbiased=False)
    return (x - m) / torch.sqrt(v + eps)
def _scatter_add(tgt, idx, src, axis=0):
    return tgt.clone().index_add_(axis, idx, src)
def _segment_sum(src, seg, n):
    out = torch.zeros((n,) + src.shape[1:], dtype=src.dtype)
    return out.index_add_(0, seg, src)
def _pad(x, pw):
    flat = tuple(v for pair in reversed(pw) for v in pair)
    return torch.nn.functional.pad(x, flat)

kernel_name = 'recurrent_scan__gqa_block_cached__dense_activation_relu__decode'

def setup_inputs():

    _w = (lambda a: (lambda t: t.to(torch.bfloat16) if t.is_floating_point() else t)(torch.as_tensor(a)))
    def _A_setup():
        B, Sq, D = 2, 1, 512
        Hq, Hkv, Sk, Dh = 32, 8, 32768, 128
        assert Hq % Hkv == 0, (Hq, Hkv)
        return {
            "x": _w((lambda *s: torch.randn(*s, dtype=torch.bfloat16) * 0.05)(B, Sq, D)),
            "k_cache": _w((lambda *s: torch.randn(*s, dtype=torch.bfloat16) * 0.8)(B, Hkv, Sk, Dh)),
            "v_cache": _w((lambda *s: torch.randn(*s, dtype=torch.bfloat16) * 0.8)(B, Hkv, Sk, Dh)),
            "wq": _w((lambda *s: torch.randn(*s, dtype=torch.bfloat16) * 0.8)(D, Hq * Dh) * (D ** -0.5)),
            "wo": _w((lambda *s: torch.randn(*s, dtype=torch.bfloat16) * 0.8)(Hq * Dh, D) * ((Hq * Dh) ** -0.5)),
        }
    _A_in = _A_setup()

    def _B_setup():
        B, S, D, Dff = 2, 1, 512, 1792
        return {
            "x": _w((lambda *s: torch.randn(*s, dtype=torch.bfloat16) * 0.05)(B, S, D)),
            "w1": _w((lambda *s: torch.randn(*s, dtype=torch.bfloat16) * 0.2)(D, Dff)),
            "w2": _w((lambda *s: torch.randn(*s, dtype=torch.bfloat16) * 0.2)(Dff, D)),
        }
    _B_in = _B_setup()

    return {
        "A_x": _A_in["x"],
        "A_k_cache": _A_in["k_cache"],
        "A_v_cache": _A_in["v_cache"],
        "A_wq": _A_in["wq"],
        "A_wo": _A_in["wo"],
        "B_x": _B_in["x"],
        "B_w1": _B_in["w1"],
        "B_w2": _B_in["w2"],
    }

def reference(A_x, A_k_cache, A_v_cache, A_wq, A_wo, B_x, B_w1, B_w2):
    def _A_ref(x, k_cache, v_cache, wq, wo):
        B, Sq, D = x.shape
        Hq, Dh = 32, 128
        Hkv = k_cache.shape[1]
        rep = Hq // Hkv
        q = (lambda x, *d: x.permute(*d))((x @ wq).reshape(B, Sq, Hq, Dh), 0, 2, 1, 3)
        k = (lambda x, n, axis: torch.repeat_interleave(x, n, dim=axis))(k_cache, rep, axis=1)
        v = (lambda x, n, axis: torch.repeat_interleave(x, n, dim=axis))(v_cache, rep, axis=1)
        scores = torch.einsum("bhqd,bhkd->bhqk", q, k) * (Dh ** -0.5)
        p = _softmax(scores, axis=-1)
        o = torch.einsum("bhqk,bhkd->bhqd", p, v)
        return (lambda x, *d: x.permute(*d))(o, 0, 2, 1, 3).reshape(B, Sq, Hq * Dh) @ wo

    def _B_ref(x, w1, w2):
        h = torch.einsum("bsd,df->bsf", x, w1)
        zero = torch.zeros_like(h)
        h = torch.maximum(h, zero)
        return torch.einsum("bsf,fd->bsd", h, w2)

    x = A_x
    xn = _layernorm(x, axis=-1)
    s = _A_ref(xn, A_k_cache, A_v_cache, A_wq, A_wo)
    g = _silu(_B_ref(xn, B_w1, B_w2))
    return x + s * g
```

```asm
; @launch grid=(256,1,1) block=(512,1,1) lds=50688
.amdgcn_target "amdgcn-amd-amdhsa--gfx950"
.text
.globl recurrent_scan__gqa_block_cached__dense_activation_relu__decode_kernel
.p2align 8
.type recurrent_scan__gqa_block_cached__dense_activation_relu__decode_kernel,@function
recurrent_scan__gqa_block_cached__dense_activation_relu__decode_kernel:
    s_cmp_ge_u32 s2, 0x100
    s_cbranch_scc1 L_FIN
    s_memrealtime s[100:101]
    s_load_dwordx16 s[64:79], s[0:1], 0
    s_load_dwordx4 s[80:83], s[0:1], 64
    s_load_dwordx2 s[84:85], s[0:1], 80
    v_lshrrev_b32 v8, 6, v0
    v_and_b32 v1, 63, v0
    s_bfe_u32 s4, s2, 0x30003
    s_bfe_u32 s5, s2, 0x10006
    s_lshr_b32 s6, s2, 7
    s_lshl_b32 s6, s6, 3
    s_and_b32 s50, s2, 7
    s_add_u32 s6, s6, s50
    s_bfe_u32 s60, s2, 0x40003
    v_readfirstlane_b32 s3, v8
    s_lshr_b32 s59, s2, 3
    s_and_b32 s50, s2, 7
    s_mul_i32 s50, s50, 14
    s_add_u32 s62, s50, s59
    s_and_b32 s50, s2, 7
    s_lshl_b32 s50, s50, 10
    s_lshl_b32 s53, s59, 6
    s_add_u32 s63, s50, s53
    s_cmp_lt_u32 s2, 112
    s_cselect_b32 s61, 1, 0
    v_lshlrev_b32 v6, 4, v1
    v_mov_b32 v254, 0
    v_mov_b32 v68, 0
    s_waitcnt lgkmcnt(0)
    s_mov_b32 s24, s64
    s_mov_b32 s25, s65
    s_mov_b32 s26, 0x800
    s_mov_b32 s27, 0x00020000
    s_cmp_ge_u32 s2, 128
    s_cbranch_scc1 L_CONS
    s_mov_b32 s16, s70
    s_mov_b32 s17, s71
    s_mov_b32 s18, 0x400000
    s_mov_b32 s19, 0x00020000
    s_mov_b32 s28, s76
    s_mov_b32 s29, s77
    s_mov_b32 s30, 0x1c0000
    s_mov_b32 s31, 0x00020000
    s_mov_b32 s32, s78
    s_mov_b32 s33, s79
    s_mov_b32 s34, 0x1c0000
    s_mov_b32 s35, 0x00020000
    s_cmp_ge_u32 s3, 2
    s_cbranch_scc1 L_P_NOX
    s_lshl_b32 s50, s3, 10
    buffer_load_dwordx4 v[8:11], v6, s[24:27], s50 offen
L_P_NOX:
    v_lshrrev_b32 v6, 2, v1
    s_lshl_b32 s50, s3, 6
    v_add_u32 v6, s50, v6
    v_mul_u32_u24 v6, 0x2000, v6
    v_and_b32 v7, 3, v1
    v_lshl_add_u32 v6, v7, 4, v6
    v_add_u32 v6, s63, v6
    s_mov_b32 s48, 0x0
    buffer_load_dwordx4 v[72:75], v6, s[16:19], s48 offen
    s_mov_b32 s48, 0x20000
    buffer_load_dwordx4 v[76:79], v6, s[16:19], s48 offen
    s_mov_b32 s48, 0x40000
    buffer_load_dwordx4 v[80:83], v6, s[16:19], s48 offen
    s_mov_b32 s48, 0x60000
    buffer_load_dwordx4 v[84:87], v6, s[16:19], s48 offen
    s_lshl_b32 s51, s6, 3
    s_add_u32 s51, s51, s4
    s_lshl_b32 s7, s5, 26
    s_lshl_b32 s50, s4, 23
    s_add_u32 s7, s7, s50
    s_mul_i32 s50, s6, 393216
    s_sub_u32 s53, s6, 8
    s_mul_i32 s53, s53, 442368
    s_add_u32 s53, s53, 3145728
    s_cmp_lt_u32 s6, 8
    s_cselect_b32 s50, s50, s53
    s_mov_b32 s57, 57344
    s_mov_b32 s58, 69632
    s_cselect_b32 s57, s57, s58
    s_mov_b32 s58, 393216
    s_mov_b32 s53, 442368
    s_cselect_b32 s58, s58, s53
    s_add_u32 s7, s7, s50
    s_mul_i32 s50, s3, s57
    s_lshl_b32 s57, s57, 2
    s_sub_u32 s53, s3, 4
    s_mul_i32 s53, s53, 40960
    s_add_u32 s57, s57, s53
    s_cmp_lt_u32 s3, 4
    s_cselect_b32 s57, s50, s57
    s_mov_b32 s52, 0x3e0293ee
    v_and_b32 v12, 15, v1
    v_lshrrev_b32 v13, 4, v1
    v_and_b32 v14, 7, v12
    v_lshlrev_b32 v14, 8, v14
    v_lshrrev_b32 v15, 3, v12
    v_lshl_add_u32 v14, v15, 4, v14
    v_lshl_add_u32 v2, v13, 5, v14
    v_add_u32 v2, s57, v2
    v_lshlrev_b32 v3, 4, v12
    v_lshl_add_u32 v3, v13, 10, v3
    v_add_u32 v3, s57, v3
    v_and_b32 v14, 1, v12
    v_lshlrev_b32 v14, 4, v14
    v_mov_b32 v15, 0xffff
    v_lshlrev_b32 v15, v14, v15
    v_and_b32 v14, 2, v12
    v_cmp_eq_u32 vcc, 0, v14
    s_nop 1
    v_cndmask_b32 v4, 0, v15, vcc
    v_cndmask_b32 v5, v15, 0, vcc
    v_lshlrev_b32 v248, 2, v1
    s_mov_b32 s44, s84
    s_mov_b32 s45, s85
    s_mov_b32 s46, 0x300000
    s_mov_b32 s47, 0x00020000
    s_add_u32 s8, s66, s7
    s_addc_u32 s9, s67, 0
    s_mov_b32 s10, 0x80000
    s_mov_b32 s11, 0x00020000
    s_add_u32 s12, s68, s7
    s_addc_u32 s13, s69, 0
    s_mov_b32 s14, 0x80000
    s_mov_b32 s15, 0x00020000
    s_mov_b32 s10, s58
    s_mov_b32 s14, s58
    s_mov_b32 s40, s82
    s_mov_b32 s41, s83
    s_mov_b32 s42, 0x100
    s_mov_b32 s43, 0x00020000
    s_mov_b32 s20, s72
    s_mov_b32 s21, s73
    s_mov_b32 s22, 0x400000
    s_mov_b32 s23, 0x00020000
    s_mov_b32 s36, s80
    s_mov_b32 s37, s81
    s_mov_b32 s38, 0x800
    s_mov_b32 s39, 0x00020000
    s_cmp_lg_u32 s3, 4
    s_cbranch_scc1 L_P_NFW
    v_mov_b32 v12, -1
    v_mov_b32 v13, -1
    v_mov_b32 v14, -1
    v_mov_b32 v15, -1
    v_lshlrev_b32 v6, 4, v1
    s_mul_i32 s50, s2, 6144
    s_add_u32 s53, s50, 4096
    buffer_store_dwordx4 v[12:15], v6, s[44:47], s50 offen offset:0 sc0 sc1
    buffer_store_dwordx4 v[12:15], v6, s[44:47], s50 offen offset:1024 sc0 sc1
    buffer_store_dwordx4 v[12:15], v6, s[44:47], s50 offen offset:2048 sc0 sc1
    buffer_store_dwordx4 v[12:15], v6, s[44:47], s50 offen offset:3072 sc0 sc1
    buffer_store_dwordx4 v[12:15], v6, s[44:47], s53 offen offset:0 sc0 sc1
    buffer_store_dwordx4 v[12:15], v6, s[44:47], s53 offen offset:1024 sc0 sc1
    s_cmp_eq_u32 s61, 0
    s_cbranch_scc1 L_P_NFW
    v_lshrrev_b32 v7, 1, v1
    v_mul_u32_u24 v7, 0xe00, v7
    v_and_b32 v9, 1, v1
    v_lshl_add_u32 v7, v9, 4, v7
    s_lshl_b32 s53, s62, 5
    buffer_load_dwordx4 v[104:107], v7, s[28:31], s53 offen
    s_add_u32 s53, s53, 114688
    buffer_load_dwordx4 v[108:111], v7, s[28:31], s53 offen
    s_add_u32 s53, s53, 114688
    buffer_load_dwordx4 v[112:115], v7, s[28:31], s53 offen
    s_add_u32 s53, s53, 114688
    buffer_load_dwordx4 v[116:119], v7, s[28:31], s53 offen
    s_add_u32 s53, s53, 114688
    buffer_load_dwordx4 v[120:123], v7, s[28:31], s53 offen
    s_add_u32 s53, s53, 114688
    buffer_load_dwordx4 v[124:127], v7, s[28:31], s53 offen
    s_add_u32 s53, s53, 114688
    buffer_load_dwordx4 v[128:131], v7, s[28:31], s53 offen
    s_add_u32 s53, s53, 114688
    buffer_load_dwordx4 v[132:135], v7, s[28:31], s53 offen
    s_add_u32 s53, s53, 114688
    buffer_load_dwordx4 v[136:139], v7, s[28:31], s53 offen
    s_add_u32 s53, s53, 114688
    buffer_load_dwordx4 v[140:143], v7, s[28:31], s53 offen
    s_add_u32 s53, s53, 114688
    buffer_load_dwordx4 v[144:147], v7, s[28:31], s53 offen
    s_add_u32 s53, s53, 114688
    buffer_load_dwordx4 v[148:151], v7, s[28:31], s53 offen
    s_add_u32 s53, s53, 114688
    buffer_load_dwordx4 v[152:155], v7, s[28:31], s53 offen
    s_add_u32 s53, s53, 114688
    buffer_load_dwordx4 v[156:159], v7, s[28:31], s53 offen
    s_add_u32 s53, s53, 114688
    buffer_load_dwordx4 v[160:163], v7, s[28:31], s53 offen
    s_add_u32 s53, s53, 114688
    buffer_load_dwordx4 v[164:167], v7, s[28:31], s53 offen
    s_lshl_b32 s50, s62, 14
    s_add_u32 s53, s50, 0
    buffer_load_dwordx4 v[168:171], v6, s[32:35], s53 offen offset:0
    buffer_load_dwordx4 v[172:175], v6, s[32:35], s53 offen offset:1024
    buffer_load_dwordx4 v[176:179], v6, s[32:35], s53 offen offset:2048
    buffer_load_dwordx4 v[180:183], v6, s[32:35], s53 offen offset:3072
    s_add_u32 s53, s50, 4096
    buffer_load_dwordx4 v[184:187], v6, s[32:35], s53 offen offset:0
    buffer_load_dwordx4 v[188:191], v6, s[32:35], s53 offen offset:1024
    buffer_load_dwordx4 v[192:195], v6, s[32:35], s53 offen offset:2048
    buffer_load_dwordx4 v[196:199], v6, s[32:35], s53 offen offset:3072
    s_add_u32 s53, s50, 8192
    buffer_load_dwordx4 v[200:203], v6, s[32:35], s53 offen offset:0
    buffer_load_dwordx4 v[204:207], v6, s[32:35], s53 offen offset:1024
    buffer_load_dwordx4 v[208:211], v6, s[32:35], s53 offen offset:2048
    buffer_load_dwordx4 v[212:215], v6, s[32:35], s53 offen offset:3072
    s_add_u32 s53, s50, 12288
    buffer_load_dwordx4 v[216:219], v6, s[32:35], s53 offen offset:0
    buffer_load_dwordx4 v[220:223], v6, s[32:35], s53 offen offset:1024
    buffer_load_dwordx4 v[224:227], v6, s[32:35], s53 offen offset:2048
    buffer_load_dwordx4 v[228:231], v6, s[32:35], s53 offen offset:3072
L_P_NFW:
    s_cmp_ge_u32 s3, 2
    s_cbranch_scc1 L_P_NOLN
    s_waitcnt vmcnt(4)
    v_lshlrev_b32 v16, 16, v8
    v_and_b32 v17, 0xffff0000, v8
    v_lshlrev_b32 v18, 16, v9
    v_and_b32 v19, 0xffff0000, v9
    v_lshlrev_b32 v20, 16, v10
    v_and_b32 v21, 0xffff0000, v10
    v_lshlrev_b32 v22, 16, v11
    v_and_b32 v23, 0xffff0000, v11
    v_add_f32 v24, v16, v17
    v_add_f32 v25, v18, v19
    v_add_f32 v26, v20, v21
    v_add_f32 v27, v22, v23
    v_add_f32 v24, v24, v25
    v_add_f32 v26, v26, v27
    v_add_f32 v24, v24, v26
    s_nop 1
    v_add_f32 v24, v24, v24 quad_perm:[1,0,3,2] row_mask:0xf bank_mask:0xf
    s_nop 1
    v_add_f32 v24, v24, v24 quad_perm:[2,3,0,1] row_mask:0xf bank_mask:0xf
    s_nop 1
    v_add_f32 v24, v24, v24 row_half_mirror row_mask:0xf bank_mask:0xf
    s_nop 1
    v_add_f32 v24, v24, v24 row_mirror row_mask:0xf bank_mask:0xf
    v_mov_b32 v25, v24
    s_nop 1
    v_permlane16_swap_b32 v24, v25
    s_nop 1
    v_add_f32 v24, v24, v25
    v_mov_b32 v25, v24
    s_nop 1
    v_permlane32_swap_b32 v24, v25
    s_nop 1
    v_add_f32 v24, v24, v25
    v_mul_f32 v24, 0x3b000000, v24
    v_mov_b32 v26, 0
    v_mov_b32 v28, 0
    v_sub_f32 v25, v16, v24
    v_sub_f32 v27, v17, v24
    v_fmac_f32 v26, v25, v25
    v_fmac_f32 v28, v27, v27
    v_sub_f32 v25, v18, v24
    v_sub_f32 v27, v19, v24
    v_fmac_f32 v26, v25, v25
    v_fmac_f32 v28, v27, v27
    v_sub_f32 v25, v20, v24
    v_sub_f32 v27, v21, v24
    v_fmac_f32 v26, v25, v25
    v_fmac_f32 v28, v27, v27
    v_sub_f32 v25, v22, v24
    v_sub_f32 v27, v23, v24
    v_fmac_f32 v26, v25, v25
    v_fmac_f32 v28, v27, v27
    v_add_f32 v26, v26, v28
    s_nop 1
    v_add_f32 v26, v26, v26 quad_perm:[1,0,3,2] row_mask:0xf bank_mask:0xf
    s_nop 1
    v_add_f32 v26, v26, v26 quad_perm:[2,3,0,1] row_mask:0xf bank_mask:0xf
    s_nop 1
    v_add_f32 v26, v26, v26 row_half_mirror row_mask:0xf bank_mask:0xf
    s_nop 1
    v_add_f32 v26, v26, v26 row_mirror row_mask:0xf bank_mask:0xf
    v_mov_b32 v25, v26
    s_nop 1
    v_permlane16_swap_b32 v26, v25
    s_nop 1
    v_add_f32 v26, v26, v25
    v_mov_b32 v25, v26
    s_nop 1
    v_permlane32_swap_b32 v26, v25
    s_nop 1
    v_add_f32 v26, v26, v25
    v_mul_f32 v26, 0x3b000000, v26
    v_cvt_pk_bf16_f32 v26, v26, v26
    v_and_b32 v26, 0xffff0000, v26
    v_add_f32 v26, 0x3727c5ac, v26
    v_cvt_pk_bf16_f32 v26, v26, v26
    v_and_b32 v26, 0xffff0000, v26
    v_sqrt_f32 v26, v26
    s_nop 0
    v_cvt_pk_bf16_f32 v26, v26, v26
    v_and_b32 v26, 0xffff0000, v26
    v_rcp_f32 v26, v26
    v_cvt_pk_bf16_f32 v24, v24, v24
    v_and_b32 v24, 0xffff0000, v24
    v_sub_f32 v16, v16, v24
    v_sub_f32 v17, v17, v24
    v_sub_f32 v18, v18, v24
    v_sub_f32 v19, v19, v24
    v_sub_f32 v20, v20, v24
    v_sub_f32 v21, v21, v24
    v_sub_f32 v22, v22, v24
    v_sub_f32 v23, v23, v24
    v_cvt_pk_bf16_f32 v16, v16, v16
    v_cvt_pk_bf16_f32 v17, v17, v17
    v_cvt_pk_bf16_f32 v18, v18, v18
    v_cvt_pk_bf16_f32 v19, v19, v19
    v_cvt_pk_bf16_f32 v20, v20, v20
    v_cvt_pk_bf16_f32 v21, v21, v21
    v_cvt_pk_bf16_f32 v22, v22, v22
    v_cvt_pk_bf16_f32 v23, v23, v23
    v_and_b32 v16, 0xffff0000, v16
    v_and_b32 v17, 0xffff0000, v17
    v_and_b32 v18, 0xffff0000, v18
    v_and_b32 v19, 0xffff0000, v19
    v_and_b32 v20, 0xffff0000, v20
    v_and_b32 v21, 0xffff0000, v21
    v_and_b32 v22, 0xffff0000, v22
    v_and_b32 v23, 0xffff0000, v23
    v_mul_f32 v16, v16, v26
    v_mul_f32 v17, v17, v26
    v_mul_f32 v18, v18, v26
    v_mul_f32 v19, v19, v26
    v_mul_f32 v20, v20, v26
    v_mul_f32 v21, v21, v26
    v_mul_f32 v22, v22, v26
    v_mul_f32 v23, v23, v26
    v_cvt_pk_bf16_f32 v16, v16, v16
    v_cvt_pk_bf16_f32 v17, v17, v17
    v_cvt_pk_bf16_f32 v18, v18, v18
    v_cvt_pk_bf16_f32 v19, v19, v19
    v_cvt_pk_bf16_f32 v20, v20, v20
    v_cvt_pk_bf16_f32 v21, v21, v21
    v_cvt_pk_bf16_f32 v22, v22, v22
    v_cvt_pk_bf16_f32 v23, v23, v23
    v_and_b32 v16, 0xffff0000, v16
    v_and_b32 v17, 0xffff0000, v17
    v_and_b32 v18, 0xffff0000, v18
    v_and_b32 v19, 0xffff0000, v19
    v_and_b32 v20, 0xffff0000, v20
    v_and_b32 v21, 0xffff0000, v21
    v_and_b32 v22, 0xffff0000, v22
    v_and_b32 v23, 0xffff0000, v23
    v_lshlrev_b32 v27, 3, v1
    s_lshl_b32 s50, s3, 11
    v_add_u32 v27, s50, v27
    v_mov_b32 v28, v16
    v_mov_b32 v29, v20
    ds_write_b64 v27, v[28:29] offset:0
    v_mov_b32 v30, v17
    v_mov_b32 v31, v21
    ds_write_b64 v27, v[30:31] offset:512
    v_mov_b32 v28, v18
    v_mov_b32 v29, v22
    ds_write_b64 v27, v[28:29] offset:1024
    v_mov_b32 v30, v19
    v_mov_b32 v31, v23
    ds_write_b64 v27, v[30:31] offset:1536
    s_waitcnt lgkmcnt(0)
L_P_NOLN:
    v_bfe_u32 v27, v1, 2, 2
    v_lshlrev_b32 v27, 9, v27
    v_lshrrev_b32 v28, 4, v1
    v_lshl_add_u32 v27, v28, 2, v27
    s_lshl_b32 s50, s3, 6
    v_add_u32 v27, s50, v27
    v_lshrrev_b32 v30, 5, v1
    v_lshlrev_b32 v30, 10, v30
    v_and_b32 v28, 3, v1
    v_lshl_add_u32 v30, v28, 5, v30
    v_bfe_u32 v28, v1, 4, 1
    v_lshl_add_u32 v30, v28, 4, v30
    s_lshl_b32 s50, s3, 7
    v_add_u32 v30, s50, v30
    s_barrier
    s_cmp_lg_u32 s3, 4
    s_cbranch_scc1 L_P_W0
    s_cmp_eq_u32 s61, 0
    s_cbranch_scc1 L_P_W6
    s_waitcnt vmcnt(38)
    s_branch L_P_QP
L_P_W6:
    s_waitcnt vmcnt(6)
    s_branch L_P_QP
L_P_W0:
    s_waitcnt vmcnt(0)
L_P_QP:
    ds_read_b32 v56, v27 offset:0
    ds_read_b32 v57, v27 offset:16
    ds_read_b32 v58, v27 offset:32
    ds_read_b32 v59, v27 offset:48
    ds_read_b32 v60, v27 offset:2048
    ds_read_b32 v61, v27 offset:2064
    ds_read_b32 v62, v27 offset:2080
    ds_read_b32 v63, v27 offset:2096
    s_waitcnt lgkmcnt(0)
    v_lshlrev_b32 v8, 16, v72
    v_and_b32 v9, 0xffff0000, v72
    v_pk_mul_f32 v[40:41], v[8:9], v[56:57] op_sel:[0,0] op_sel_hi:[1,0]
    v_pk_mul_f32 v[48:49], v[8:9], v[60:61] op_sel:[0,0] op_sel_hi:[1,0]
    v_lshlrev_b32 v10, 16, v73
    v_and_b32 v11, 0xffff0000, v73
    v_pk_mul_f32 v[42:43], v[10:11], v[56:57] op_sel:[0,0] op_sel_hi:[1,0]
    v_pk_mul_f32 v[50:51], v[10:11], v[60:61] op_sel:[0,0] op_sel_hi:[1,0]
    v_lshlrev_b32 v12, 16, v74
    v_and_b32 v13, 0xffff0000, v74
    v_pk_mul_f32 v[44:45], v[12:13], v[56:57] op_sel:[0,0] op_sel_hi:[1,0]
    v_pk_mul_f32 v[52:53], v[12:13], v[60:61] op_sel:[0,0] op_sel_hi:[1,0]
    v_lshlrev_b32 v14, 16, v75
    v_and_b32 v15, 0xffff0000, v75
    v_pk_mul_f32 v[46:47], v[14:15], v[56:57] op_sel:[0,0] op_sel_hi:[1,0]
    v_pk_mul_f32 v[54:55], v[14:15], v[60:61] op_sel:[0,0] op_sel_hi:[1,0]
    v_lshlrev_b32 v8, 16, v76
    v_and_b32 v9, 0xffff0000, v76
    v_pk_fma_f32 v[40:41], v[8:9], v[56:57], v[40:41] op_sel:[0,1,0] op_sel_hi:[1,1,1]
    v_pk_fma_f32 v[48:49], v[8:9], v[60:61], v[48:49] op_sel:[0,1,0] op_sel_hi:[1,1,1]
    v_lshlrev_b32 v10, 16, v77
    v_and_b32 v11, 0xffff0000, v77
    v_pk_fma_f32 v[42:43], v[10:11], v[56:57], v[42:43] op_sel:[0,1,0] op_sel_hi:[1,1,1]
    v_pk_fma_f32 v[50:51], v[10:11], v[60:61], v[50:51] op_sel:[0,1,0] op_sel_hi:[1,1,1]
    v_lshlrev_b32 v12, 16, v78
    v_and_b32 v13, 0xffff0000, v78
    v_pk_fma_f32 v[44:45], v[12:13], v[56:57], v[44:45] op_sel:[0,1,0] op_sel_hi:[1,1,1]
    v_pk_fma_f32 v[52:53], v[12:13], v[60:61], v[52:53] op_sel:[0,1,0] op_sel_hi:[1,1,1]
    v_lshlrev_b32 v14, 16, v79
    v_and_b32 v15, 0xffff0000, v79
    v_pk_fma_f32 v[46:47], v[14:15], v[56:57], v[46:47] op_sel:[0,1,0] op_sel_hi:[1,1,1]
    v_pk_fma_f32 v[54:55], v[14:15], v[60:61], v[54:55] op_sel:[0,1,0] op_sel_hi:[1,1,1]
    v_lshlrev_b32 v8, 16, v80
    v_and_b32 v9, 0xffff0000, v80
    v_pk_fma_f32 v[40:41], v[8:9], v[58:59], v[40:41] op_sel:[0,0,0] op_sel_hi:[1,0,1]
    v_pk_fma_f32 v[48:49], v[8:9], v[62:63], v[48:49] op_sel:[0,0,0] op_sel_hi:[1,0,1]
    v_lshlrev_b32 v10, 16, v81
    v_and_b32 v11, 0xffff0000, v81
    v_pk_fma_f32 v[42:43], v[10:11], v[58:59], v[42:43] op_sel:[0,0,0] op_sel_hi:[1,0,1]
    v_pk_fma_f32 v[50:51], v[10:11], v[62:63], v[50:51] op_sel:[0,0,0] op_sel_hi:[1,0,1]
    v_lshlrev_b32 v12, 16, v82
    v_and_b32 v13, 0xffff0000, v82
    v_pk_fma_f32 v[44:45], v[12:13], v[58:59], v[44:45] op_sel:[0,0,0] op_sel_hi:[1,0,1]
    v_pk_fma_f32 v[52:53], v[12:13], v[62:63], v[52:53] op_sel:[0,0,0] op_sel_hi:[1,0,1]
    v_lshlrev_b32 v14, 16, v83
    v_and_b32 v15, 0xffff0000, v83
    v_pk_fma_f32 v[46:47], v[14:15], v[58:59], v[46:47] op_sel:[0,0,0] op_sel_hi:[1,0,1]
    v_pk_fma_f32 v[54:55], v[14:15], v[62:63], v[54:55] op_sel:[0,0,0] op_sel_hi:[1,0,1]
    v_lshlrev_b32 v8, 16, v84
    v_and_b32 v9, 0xffff0000, v84
    v_pk_fma_f32 v[40:41], v[8:9], v[58:59], v[40:41] op_sel:[0,1,0] op_sel_hi:[1,1,1]
    v_pk_fma_f32 v[48:49], v[8:9], v[62:63], v[48:49] op_sel:[0,1,0] op_sel_hi:[1,1,1]
    v_lshlrev_b32 v10, 16, v85
    v_and_b32 v11, 0xffff0000, v85
    v_pk_fma_f32 v[42:43], v[10:11], v[58:59], v[42:43] op_sel:[0,1,0] op_sel_hi:[1,1,1]
    v_pk_fma_f32 v[50:51], v[10:11], v[62:63], v[50:51] op_sel:[0,1,0] op_sel_hi:[1,1,1]
    v_lshlrev_b32 v12, 16, v86
    v_and_b32 v13, 0xffff0000, v86
    v_pk_fma_f32 v[44:45], v[12:13], v[58:59], v[44:45] op_sel:[0,1,0] op_sel_hi:[1,1,1]
    v_pk_fma_f32 v[52:53], v[12:13], v[62:63], v[52:53] op_sel:[0,1,0] op_sel_hi:[1,1,1]
    v_lshlrev_b32 v14, 16, v87
    v_and_b32 v15, 0xffff0000, v87
    v_pk_fma_f32 v[46:47], v[14:15], v[58:59], v[46:47] op_sel:[0,1,0] op_sel_hi:[1,1,1]
    v_pk_fma_f32 v[54:55], v[14:15], v[62:63], v[54:55] op_sel:[0,1,0] op_sel_hi:[1,1,1]
    s_nop 1
    v_permlane32_swap_b32 v40, v48
    v_permlane32_swap_b32 v41, v49
    v_permlane32_swap_b32 v42, v50
    v_permlane32_swap_b32 v43, v51
    v_permlane32_swap_b32 v44, v52
    v_permlane32_swap_b32 v45, v53
    v_permlane32_swap_b32 v46, v54
    v_permlane32_swap_b32 v47, v55
    s_nop 1
    v_add_f32 v40, v40, v48
    v_add_f32 v41, v41, v49
    v_add_f32 v42, v42, v50
    v_add_f32 v43, v43, v51
    v_add_f32 v44, v44, v52
    v_add_f32 v45, v45, v53
    v_add_f32 v46, v46, v54
    v_add_f32 v47, v47, v55
    s_nop 1
    v_permlane16_swap_b32 v40, v44
    v_permlane16_swap_b32 v41, v45
    v_permlane16_swap_b32 v42, v46
    v_permlane16_swap_b32 v43, v47
    s_nop 1
    v_add_f32 v40, v40, v44
    v_add_f32 v41, v41, v45
    v_add_f32 v42, v42, v46
    v_add_f32 v43, v43, v47
    s_nop 1
    v_add_f32 v40, v40, v40 row_ror:4 row_mask:0xf bank_mask:0xf
    v_add_f32 v41, v41, v41 row_ror:4 row_mask:0xf bank_mask:0xf
    v_add_f32 v42, v42, v42 row_ror:4 row_mask:0xf bank_mask:0xf
    v_add_f32 v43, v43, v43 row_ror:4 row_mask:0xf bank_mask:0xf
    s_nop 1
    v_add_f32 v40, v40, v40 row_ror:8 row_mask:0xf bank_mask:0xf
    v_add_f32 v41, v41, v41 row_ror:8 row_mask:0xf bank_mask:0xf
    v_add_f32 v42, v42, v42 row_ror:8 row_mask:0xf bank_mask:0xf
    v_add_f32 v43, v43, v43 row_ror:8 row_mask:0xf bank_mask:0xf
    s_mov_b32 exec_lo, 0x000f000f
    s_mov_b32 exec_hi, 0x000f000f
    ds_write_b128 v30, v[40:43] offset:4096
    s_mov_b64 exec, -1
    s_waitcnt lgkmcnt(0)
    s_barrier
    s_cmp_ge_u32 s3, 4
    s_cbranch_scc1 L_P_BARB
    s_and_b32 s55, s3, 1
    s_lshr_b32 s56, s3, 1
    v_and_b32 v9, 3, v1
    v_lshlrev_b32 v8, 4, v9
    s_lshl_b32 s50, s55, 10
    s_lshl_b32 s53, s56, 6
    s_add_u32 s50, s50, s53
    v_add_u32 v8, s50, v8
    ds_read_b128 v[16:19], v8 offset:4096
    ds_read_b128 v[20:23], v8 offset:4224
    ds_read_b128 v[24:27], v8 offset:4352
    ds_read_b128 v[28:31], v8 offset:4480
    ds_read_b128 v[32:35], v8 offset:4608
    ds_read_b128 v[36:39], v8 offset:4736
    ds_read_b128 v[40:43], v8 offset:4864
    ds_read_b128 v[44:47], v8 offset:4992
    v_lshrrev_b32 v10, 2, v1
    v_lshlrev_b32 v10, 15, v10
    v_lshl_add_u32 v10, v9, 4, v10
    s_lshl_b32 s55, s55, 3
    s_and_b32 s53, s2, 7
    s_add_u32 s55, s55, s53
    s_lshl_b32 s50, s55, 11
    s_lshl_b32 s53, s59, 7
    s_add_u32 s50, s50, s53
    s_lshl_b32 s53, s56, 6
    s_add_u32 s50, s50, s53
    s_add_u32 s50, s50, 0x240000
    s_waitcnt lgkmcnt(0)
    v_add_f32 v16, v16, v20
    v_add_f32 v17, v17, v21
    v_add_f32 v18, v18, v22
    v_add_f32 v19, v19, v23
    v_add_f32 v16, v16, v24
    v_add_f32 v17, v17, v25
    v_add_f32 v18, v18, v26
    v_add_f32 v19, v19, v27
    v_add_f32 v16, v16, v28
    v_add_f32 v17, v17, v29
    v_add_f32 v18, v18, v30
    v_add_f32 v19, v19, v31
    v_add_f32 v16, v16, v32
    v_add_f32 v17, v17, v33
    v_add_f32 v18, v18, v34
    v_add_f32 v19, v19, v35
    v_add_f32 v16, v16, v36
    v_add_f32 v17, v17, v37
    v_add_f32 v18, v18, v38
    v_add_f32 v19, v19, v39
    v_add_f32 v16, v16, v40
    v_add_f32 v17, v17, v41
    v_add_f32 v18, v18, v42
    v_add_f32 v19, v19, v43
    v_add_f32 v16, v16, v44
    v_add_f32 v17, v17, v45
    v_add_f32 v18, v18, v46
    v_add_f32 v19, v19, v47
    v_cvt_pk_bf16_f32 v16, v16, v17
    v_cvt_pk_bf16_f32 v17, v18, v19
    v_mov_b32 v18, s100
    v_mov_b32 v19, s101
    buffer_store_dwordx4 v[16:19], v10, s[44:47], s50 offen sc0 sc1
L_P_BARB:
    s_barrier
    s_cmp_lg_u32 s3, 4
    s_cbranch_scc1 L_PRE
    s_cmp_eq_u32 s61, 0
    s_cbranch_scc1 L_PRE
    v_lshlrev_b32 v6, 4, v1
    v_bfe_u32 v27, v1, 1, 2
    v_lshlrev_b32 v27, 9, v27
    v_lshrrev_b32 v28, 3, v1
    v_lshl_add_u32 v27, v28, 2, v27
    s_lshl_b32 s50, s3, 6
    v_add_u32 v27, s50, v27
    v_lshrrev_b32 v30, 5, v1
    v_lshlrev_b32 v30, 10, v30
    v_and_b32 v28, 1, v1
    v_lshl_add_u32 v30, v28, 5, v30
    v_bfe_u32 v28, v1, 4, 1
    v_lshl_add_u32 v30, v28, 4, v30
    s_lshl_b32 s50, s3, 6
    v_add_u32 v30, s50, v30
    v_subrev_u32 v26, 256, v27
    v_add_u32 v25, 0x800, v26
    ds_read2_b32 v[56:57], v26 offset0:0 offset1:8
    ds_read2_b32 v[58:59], v26 offset0:16 offset1:24
    ds_read2_b32 v[60:61], v26 offset0:32 offset1:40
    ds_read2_b32 v[62:63], v26 offset0:48 offset1:56
    ds_read2_b32 v[64:65], v26 offset0:64 offset1:72
    ds_read2_b32 v[66:67], v26 offset0:80 offset1:88
    ds_read2_b32 v[68:69], v26 offset0:96 offset1:104
    ds_read2_b32 v[70:71], v26 offset0:112 offset1:120
    ds_read2_b32 v[72:73], v25 offset0:0 offset1:8
    ds_read2_b32 v[74:75], v25 offset0:16 offset1:24
    ds_read2_b32 v[76:77], v25 offset0:32 offset1:40
    ds_read2_b32 v[78:79], v25 offset0:48 offset1:56
    ds_read2_b32 v[80:81], v25 offset0:64 offset1:72
    ds_read2_b32 v[82:83], v25 offset0:80 offset1:88
    ds_read2_b32 v[84:85], v25 offset0:96 offset1:104
    ds_read2_b32 v[86:87], v25 offset0:112 offset1:120
    s_waitcnt lgkmcnt(0)
    s_waitcnt vmcnt(16)
    v_lshlrev_b32 v8, 16, v104
    v_and_b32 v9, 0xffff0000, v104
    v_pk_mul_f32 v[40:41], v[8:9], v[56:57] op_sel:[0,0] op_sel_hi:[1,0]
    v_pk_mul_f32 v[48:49], v[8:9], v[72:73] op_sel:[0,0] op_sel_hi:[1,0]
    v_lshlrev_b32 v10, 16, v105
    v_and_b32 v11, 0xffff0000, v105
    v_pk_mul_f32 v[42:43], v[10:11], v[56:57] op_sel:[0,0] op_sel_hi:[1,0]
    v_pk_mul_f32 v[50:51], v[10:11], v[72:73] op_sel:[0,0] op_sel_hi:[1,0]
    v_lshlrev_b32 v12, 16, v106
    v_and_b32 v13, 0xffff0000, v106
    v_pk_mul_f32 v[44:45], v[12:13], v[56:57] op_sel:[0,0] op_sel_hi:[1,0]
    v_pk_mul_f32 v[52:53], v[12:13], v[72:73] op_sel:[0,0] op_sel_hi:[1,0]
    v_lshlrev_b32 v14, 16, v107
    v_and_b32 v15, 0xffff0000, v107
    v_pk_mul_f32 v[46:47], v[14:15], v[56:57] op_sel:[0,0] op_sel_hi:[1,0]
    v_pk_mul_f32 v[54:55], v[14:15], v[72:73] op_sel:[0,0] op_sel_hi:[1,0]
    v_lshlrev_b32 v8, 16, v108
    v_and_b32 v9, 0xffff0000, v108
    v_pk_fma_f32 v[40:41], v[8:9], v[56:57], v[40:41] op_sel:[0,1,0] op_sel_hi:[1,1,1]
    v_pk_fma_f32 v[48:49], v[8:9], v[72:73], v[48:49] op_sel:[0,1,0] op_sel_hi:[1,1,1]
    v_lshlrev_b32 v10, 16, v109
    v_and_b32 v11, 0xffff0000, v109
    v_pk_fma_f32 v[42:43], v[10:11], v[56:57], v[42:43] op_sel:[0,1,0] op_sel_hi:[1,1,1]
    v_pk_fma_f32 v[50:51], v[10:11], v[72:73], v[50:51] op_sel:[0,1,0] op_sel_hi:[1,1,1]
    v_lshlrev_b32 v12, 16, v110
    v_and_b32 v13, 0xffff0000, v110
    v_pk_fma_f32 v[44:45], v[12:13], v[56:57], v[44:45] op_sel:[0,1,0] op_sel_hi:[1,1,1]
    v_pk_fma_f32 v[52:53], v[12:13], v[72:73], v[52:53] op_sel:[0,1,0] op_sel_hi:[1,1,1]
    v_lshlrev_b32 v14, 16, v111
    v_and_b32 v15, 0xffff0000, v111
    v_pk_fma_f32 v[46:47], v[14:15], v[56:57], v[46:47] op_sel:[0,1,0] op_sel_hi:[1,1,1]
    v_pk_fma_f32 v[54:55], v[14:15], v[72:73], v[54:55] op_sel:[0,1,0] op_sel_hi:[1,1,1]
    v_lshlrev_b32 v8, 16, v112
    v_and_b32 v9, 0xffff0000, v112
    v_pk_fma_f32 v[40:41], v[8:9], v[58:59], v[40:41] op_sel:[0,0,0] op_sel_hi:[1,0,1]
    v_pk_fma_f32 v[48:49], v[8:9], v[74:75], v[48:49] op_sel:[0,0,0] op_sel_hi:[1,0,1]
    v_lshlrev_b32 v10, 16, v113
    v_and_b32 v11, 0xffff0000, v113
    v_pk_fma_f32 v[42:43], v[10:11], v[58:59], v[42:43] op_sel:[0,0,0] op_sel_hi:[1,0,1]
    v_pk_fma_f32 v[50:51], v[10:11], v[74:75], v[50:51] op_sel:[0,0,0] op_sel_hi:[1,0,1]
    v_lshlrev_b32 v12, 16, v114
    v_and_b32 v13, 0xffff0000, v114
    v_pk_fma_f32 v[44:45], v[12:13], v[58:59], v[44:45] op_sel:[0,0,0] op_sel_hi:[1,0,1]
    v_pk_fma_f32 v[52:53], v[12:13], v[74:75], v[52:53] op_sel:[0,0,0] op_sel_hi:[1,0,1]
    v_lshlrev_b32 v14, 16, v115
    v_and_b32 v15, 0xffff0000, v115
    v_pk_fma_f32 v[46:47], v[14:15], v[58:59], v[46:47] op_sel:[0,0,0] op_sel_hi:[1,0,1]
    v_pk_fma_f32 v[54:55], v[14:15], v[74:75], v[54:55] op_sel:[0,0,0] op_sel_hi:[1,0,1]
    v_lshlrev_b32 v8, 16, v116
    v_and_b32 v9, 0xffff0000, v116
    v_pk_fma_f32 v[40:41], v[8:9], v[58:59], v[40:41] op_sel:[0,1,0] op_sel_hi:[1,1,1]
    v_pk_fma_f32 v[48:49], v[8:9], v[74:75], v[48:49] op_sel:[0,1,0] op_sel_hi:[1,1,1]
    v_lshlrev_b32 v10, 16, v117
    v_and_b32 v11, 0xffff0000, v117
    v_pk_fma_f32 v[42:43], v[10:11], v[58:59], v[42:43] op_sel:[0,1,0] op_sel_hi:[1,1,1]
    v_pk_fma_f32 v[50:51], v[10:11], v[74:75], v[50:51] op_sel:[0,1,0] op_sel_hi:[1,1,1]
    v_lshlrev_b32 v12, 16, v118
    v_and_b32 v13, 0xffff0000, v118
    v_pk_fma_f32 v[44:45], v[12:13], v[58:59], v[44:45] op_sel:[0,1,0] op_sel_hi:[1,1,1]
    v_pk_fma_f32 v[52:53], v[12:13], v[74:75], v[52:53] op_sel:[0,1,0] op_sel_hi:[1,1,1]
    v_lshlrev_b32 v14, 16, v119
    v_and_b32 v15, 0xffff0000, v119
    v_pk_fma_f32 v[46:47], v[14:15], v[58:59], v[46:47] op_sel:[0,1,0] op_sel_hi:[1,1,1]
    v_pk_fma_f32 v[54:55], v[14:15], v[74:75], v[54:55] op_sel:[0,1,0] op_sel_hi:[1,1,1]
    v_lshlrev_b32 v8, 16, v120
    v_and_b32 v9, 0xffff0000, v120
    v_pk_fma_f32 v[40:41], v[8:9], v[60:61], v[40:41] op_sel:[0,0,0] op_sel_hi:[1,0,1]
    v_pk_fma_f32 v[48:49], v[8:9], v[76:77], v[48:49] op_sel:[0,0,0] op_sel_hi:[1,0,1]
    v_lshlrev_b32 v10, 16, v121
    v_and_b32 v11, 0xffff0000, v121
    v_pk_fma_f32 v[42:43], v[10:11], v[60:61], v[42:43] op_sel:[0,0,0] op_sel_hi:[1,0,1]
    v_pk_fma_f32 v[50:51], v[10:11], v[76:77], v[50:51] op_sel:[0,0,0] op_sel_hi:[1,0,1]
    v_lshlrev_b32 v12, 16, v122
    v_and_b32 v13, 0xffff0000, v122
    v_pk_fma_f32 v[44:45], v[12:13], v[60:61], v[44:45] op_sel:[0,0,0] op_sel_hi:[1,0,1]
    v_pk_fma_f32 v[52:53], v[12:13], v[76:77], v[52:53] op_sel:[0,0,0] op_sel_hi:[1,0,1]
    v_lshlrev_b32 v14, 16, v123
    v_and_b32 v15, 0xffff0000, v123
    v_pk_fma_f32 v[46:47], v[14:15], v[60:61], v[46:47] op_sel:[0,0,0] op_sel_hi:[1,0,1]
    v_pk_fma_f32 v[54:55], v[14:15], v[76:77], v[54:55] op_sel:[0,0,0] op_sel_hi:[1,0,1]
    v_lshlrev_b32 v8, 16, v124
    v_and_b32 v9, 0xffff0000, v124
    v_pk_fma_f32 v[40:41], v[8:9], v[60:61], v[40:41] op_sel:[0,1,0] op_sel_hi:[1,1,1]
    v_pk_fma_f32 v[48:49], v[8:9], v[76:77], v[48:49] op_sel:[0,1,0] op_sel_hi:[1,1,1]
    v_lshlrev_b32 v10, 16, v125
    v_and_b32 v11, 0xffff0000, v125
    v_pk_fma_f32 v[42:43], v[10:11], v[60:61], v[42:43] op_sel:[0,1,0] op_sel_hi:[1,1,1]
    v_pk_fma_f32 v[50:51], v[10:11], v[76:77], v[50:51] op_sel:[0,1,0] op_sel_hi:[1,1,1]
    v_lshlrev_b32 v12, 16, v126
    v_and_b32 v13, 0xffff0000, v126
    v_pk_fma_f32 v[44:45], v[12:13], v[60:61], v[44:45] op_sel:[0,1,0] op_sel_hi:[1,1,1]
    v_pk_fma_f32 v[52:53], v[12:13], v[76:77], v[52:53] op_sel:[0,1,0] op_sel_hi:[1,1,1]
    v_lshlrev_b32 v14, 16, v127
    v_and_b32 v15, 0xffff0000, v127
    v_pk_fma_f32 v[46:47], v[14:15], v[60:61], v[46:47] op_sel:[0,1,0] op_sel_hi:[1,1,1]
    v_pk_fma_f32 v[54:55], v[14:15], v[76:77], v[54:55] op_sel:[0,1,0] op_sel_hi:[1,1,1]
    v_lshlrev_b32 v8, 16, v128
    v_and_b32 v9, 0xffff0000, v128
    v_pk_fma_f32 v[40:41], v[8:9], v[62:63], v[40:41] op_sel:[0,0,0] op_sel_hi:[1,0,1]
    v_pk_fma_f32 v[48:49], v[8:9], v[78:79], v[48:49] op_sel:[0,0,0] op_sel_hi:[1,0,1]
    v_lshlrev_b32 v10, 16, v129
    v_and_b32 v11, 0xffff0000, v129
    v_pk_fma_f32 v[42:43], v[10:11], v[62:63], v[42:43] op_sel:[0,0,0] op_sel_hi:[1,0,1]
    v_pk_fma_f32 v[50:51], v[10:11], v[78:79], v[50:51] op_sel:[0,0,0] op_sel_hi:[1,0,1]
    v_lshlrev_b32 v12, 16, v130
    v_and_b32 v13, 0xffff0000, v130
    v_pk_fma_f32 v[44:45], v[12:13], v[62:63], v[44:45] op_sel:[0,0,0] op_sel_hi:[1,0,1]
    v_pk_fma_f32 v[52:53], v[12:13], v[78:79], v[52:53] op_sel:[0,0,0] op_sel_hi:[1,0,1]
    v_lshlrev_b32 v14, 16, v131
    v_and_b32 v15, 0xffff0000, v131
    v_pk_fma_f32 v[46:47], v[14:15], v[62:63], v[46:47] op_sel:[0,0,0] op_sel_hi:[1,0,1]
    v_pk_fma_f32 v[54:55], v[14:15], v[78:79], v[54:55] op_sel:[0,0,0] op_sel_hi:[1,0,1]
    v_lshlrev_b32 v8, 16, v132
    v_and_b32 v9, 0xffff0000, v132
    v_pk_fma_f32 v[40:41], v[8:9], v[62:63], v[40:41] op_sel:[0,1,0] op_sel_hi:[1,1,1]
    v_pk_fma_f32 v[48:49], v[8:9], v[78:79], v[48:49] op_sel:[0,1,0] op_sel_hi:[1,1,1]
    v_lshlrev_b32 v10, 16, v133
    v_and_b32 v11, 0xffff0000, v133
    v_pk_fma_f32 v[42:43], v[10:11], v[62:63], v[42:43] op_sel:[0,1,0] op_sel_hi:[1,1,1]
    v_pk_fma_f32 v[50:51], v[10:11], v[78:79], v[50:51] op_sel:[0,1,0] op_sel_hi:[1,1,1]
    v_lshlrev_b32 v12, 16, v134
    v_and_b32 v13, 0xffff0000, v134
    v_pk_fma_f32 v[44:45], v[12:13], v[62:63], v[44:45] op_sel:[0,1,0] op_sel_hi:[1,1,1]
    v_pk_fma_f32 v[52:53], v[12:13], v[78:79], v[52:53] op_sel:[0,1,0] op_sel_hi:[1,1,1]
    v_lshlrev_b32 v14, 16, v135
    v_and_b32 v15, 0xffff0000, v135
    v_pk_fma_f32 v[46:47], v[14:15], v[62:63], v[46:47] op_sel:[0,1,0] op_sel_hi:[1,1,1]
    v_pk_fma_f32 v[54:55], v[14:15], v[78:79], v[54:55] op_sel:[0,1,0] op_sel_hi:[1,1,1]
    v_lshlrev_b32 v8, 16, v136
    v_and_b32 v9, 0xffff0000, v136
    v_pk_fma_f32 v[40:41], v[8:9], v[64:65], v[40:41] op_sel:[0,0,0] op_sel_hi:[1,0,1]
    v_pk_fma_f32 v[48:49], v[8:9], v[80:81], v[48:49] op_sel:[0,0,0] op_sel_hi:[1,0,1]
    v_lshlrev_b32 v10, 16, v137
    v_and_b32 v11, 0xffff0000, v137
    v_pk_fma_f32 v[42:43], v[10:11], v[64:65], v[42:43] op_sel:[0,0,0] op_sel_hi:[1,0,1]
    v_pk_fma_f32 v[50:51], v[10:11], v[80:81], v[50:51] op_sel:[0,0,0] op_sel_hi:[1,0,1]
    v_lshlrev_b32 v12, 16, v138
    v_and_b32 v13, 0xffff0000, v138
    v_pk_fma_f32 v[44:45], v[12:13], v[64:65], v[44:45] op_sel:[0,0,0] op_sel_hi:[1,0,1]
    v_pk_fma_f32 v[52:53], v[12:13], v[80:81], v[52:53] op_sel:[0,0,0] op_sel_hi:[1,0,1]
    v_lshlrev_b32 v14, 16, v139
    v_and_b32 v15, 0xffff0000, v139
    v_pk_fma_f32 v[46:47], v[14:15], v[64:65], v[46:47] op_sel:[0,0,0] op_sel_hi:[1,0,1]
    v_pk_fma_f32 v[54:55], v[14:15], v[80:81], v[54:55] op_sel:[0,0,0] op_sel_hi:[1,0,1]
    v_lshlrev_b32 v8, 16, v140
    v_and_b32 v9, 0xffff0000, v140
    v_pk_fma_f32 v[40:41], v[8:9], v[64:65], v[40:41] op_sel:[0,1,0] op_sel_hi:[1,1,1]
    v_pk_fma_f32 v[48:49], v[8:9], v[80:81], v[48:49] op_sel:[0,1,0] op_sel_hi:[1,1,1]
    v_lshlrev_b32 v10, 16, v141
    v_and_b32 v11, 0xffff0000, v141
    v_pk_fma_f32 v[42:43], v[10:11], v[64:65], v[42:43] op_sel:[0,1,0] op_sel_hi:[1,1,1]
    v_pk_fma_f32 v[50:51], v[10:11], v[80:81], v[50:51] op_sel:[0,1,0] op_sel_hi:[1,1,1]
    v_lshlrev_b32 v12, 16, v142
    v_and_b32 v13, 0xffff0000, v142
    v_pk_fma_f32 v[44:45], v[12:13], v[64:65], v[44:45] op_sel:[0,1,0] op_sel_hi:[1,1,1]
    v_pk_fma_f32 v[52:53], v[12:13], v[80:81], v[52:53] op_sel:[0,1,0] op_sel_hi:[1,1,1]
    v_lshlrev_b32 v14, 16, v143
    v_and_b32 v15, 0xffff0000, v143
    v_pk_fma_f32 v[46:47], v[14:15], v[64:65], v[46:47] op_sel:[0,1,0] op_sel_hi:[1,1,1]
    v_pk_fma_f32 v[54:55], v[14:15], v[80:81], v[54:55] op_sel:[0,1,0] op_sel_hi:[1,1,1]
    v_lshlrev_b32 v8, 16, v144
    v_and_b32 v9, 0xffff0000, v144
    v_pk_fma_f32 v[40:41], v[8:9], v[66:67], v[40:41] op_sel:[0,0,0] op_sel_hi:[1,0,1]
    v_pk_fma_f32 v[48:49], v[8:9], v[82:83], v[48:49] op_sel:[0,0,0] op_sel_hi:[1,0,1]
    v_lshlrev_b32 v10, 16, v145
    v_and_b32 v11, 0xffff0000, v145
    v_pk_fma_f32 v[42:43], v[10:11], v[66:67], v[42:43] op_sel:[0,0,0] op_sel_hi:[1,0,1]
    v_pk_fma_f32 v[50:51], v[10:11], v[82:83], v[50:51] op_sel:[0,0,0] op_sel_hi:[1,0,1]
    v_lshlrev_b32 v12, 16, v146
    v_and_b32 v13, 0xffff0000, v146
    v_pk_fma_f32 v[44:45], v[12:13], v[66:67], v[44:45] op_sel:[0,0,0] op_sel_hi:[1,0,1]
    v_pk_fma_f32 v[52:53], v[12:13], v[82:83], v[52:53] op_sel:[0,0,0] op_sel_hi:[1,0,1]
    v_lshlrev_b32 v14, 16, v147
    v_and_b32 v15, 0xffff0000, v147
    v_pk_fma_f32 v[46:47], v[14:15], v[66:67], v[46:47] op_sel:[0,0,0] op_sel_hi:[1,0,1]
    v_pk_fma_f32 v[54:55], v[14:15], v[82:83], v[54:55] op_sel:[0,0,0] op_sel_hi:[1,0,1]
    v_lshlrev_b32 v8, 16, v148
    v_and_b32 v9, 0xffff0000, v148
    v_pk_fma_f32 v[40:41], v[8:9], v[66:67], v[40:41] op_sel:[0,1,0] op_sel_hi:[1,1,1]
    v_pk_fma_f32 v[48:49], v[8:9], v[82:83], v[48:49] op_sel:[0,1,0] op_sel_hi:[1,1,1]
    v_lshlrev_b32 v10, 16, v149
    v_and_b32 v11, 0xffff0000, v149
    v_pk_fma_f32 v[42:43], v[10:11], v[66:67], v[42:43] op_sel:[0,1,0] op_sel_hi:[1,1,1]
    v_pk_fma_f32 v[50:51], v[10:11], v[82:83], v[50:51] op_sel:[0,1,0] op_sel_hi:[1,1,1]
    v_lshlrev_b32 v12, 16, v150
    v_and_b32 v13, 0xffff0000, v150
    v_pk_fma_f32 v[44:45], v[12:13], v[66:67], v[44:45] op_sel:[0,1,0] op_sel_hi:[1,1,1]
    v_pk_fma_f32 v[52:53], v[12:13], v[82:83], v[52:53] op_sel:[0,1,0] op_sel_hi:[1,1,1]
    v_lshlrev_b32 v14, 16, v151
    v_and_b32 v15, 0xffff0000, v151
    v_pk_fma_f32 v[46:47], v[14:15], v[66:67], v[46:47] op_sel:[0,1,0] op_sel_hi:[1,1,1]
    v_pk_fma_f32 v[54:55], v[14:15], v[82:83], v[54:55] op_sel:[0,1,0] op_sel_hi:[1,1,1]
    v_lshlrev_b32 v8, 16, v152
    v_and_b32 v9, 0xffff0000, v152
    v_pk_fma_f32 v[40:41], v[8:9], v[68:69], v[40:41] op_sel:[0,0,0] op_sel_hi:[1,0,1]
    v_pk_fma_f32 v[48:49], v[8:9], v[84:85], v[48:49] op_sel:[0,0,0] op_sel_hi:[1,0,1]
    v_lshlrev_b32 v10, 16, v153
    v_and_b32 v11, 0xffff0000, v153
    v_pk_fma_f32 v[42:43], v[10:11], v[68:69], v[42:43] op_sel:[0,0,0] op_sel_hi:[1,0,1]
    v_pk_fma_f32 v[50:51], v[10:11], v[84:85], v[50:51] op_sel:[0,0,0] op_sel_hi:[1,0,1]
    v_lshlrev_b32 v12, 16, v154
    v_and_b32 v13, 0xffff0000, v154
    v_pk_fma_f32 v[44:45], v[12:13], v[68:69], v[44:45] op_sel:[0,0,0] op_sel_hi:[1,0,1]
    v_pk_fma_f32 v[52:53], v[12:13], v[84:85], v[52:53] op_sel:[0,0,0] op_sel_hi:[1,0,1]
    v_lshlrev_b32 v14, 16, v155
    v_and_b32 v15, 0xffff0000, v155
    v_pk_fma_f32 v[46:47], v[14:15], v[68:69], v[46:47] op_sel:[0,0,0] op_sel_hi:[1,0,1]
    v_pk_fma_f32 v[54:55], v[14:15], v[84:85], v[54:55] op_sel:[0,0,0] op_sel_hi:[1,0,1]
    v_lshlrev_b32 v8, 16, v156
    v_and_b32 v9, 0xffff0000, v156
    v_pk_fma_f32 v[40:41], v[8:9], v[68:69], v[40:41] op_sel:[0,1,0] op_sel_hi:[1,1,1]
    v_pk_fma_f32 v[48:49], v[8:9], v[84:85], v[48:49] op_sel:[0,1,0] op_sel_hi:[1,1,1]
    v_lshlrev_b32 v10, 16, v157
    v_and_b32 v11, 0xffff0000, v157
    v_pk_fma_f32 v[42:43], v[10:11], v[68:69], v[42:43] op_sel:[0,1,0] op_sel_hi:[1,1,1]
    v_pk_fma_f32 v[50:51], v[10:11], v[84:85], v[50:51] op_sel:[0,1,0] op_sel_hi:[1,1,1]
    v_lshlrev_b32 v12, 16, v158
    v_and_b32 v13, 0xffff0000, v158
    v_pk_fma_f32 v[44:45], v[12:13], v[68:69], v[44:45] op_sel:[0,1,0] op_sel_hi:[1,1,1]
    v_pk_fma_f32 v[52:53], v[12:13], v[84:85], v[52:53] op_sel:[0,1,0] op_sel_hi:[1,1,1]
    v_lshlrev_b32 v14, 16, v159
    v_and_b32 v15, 0xffff0000, v159
    v_pk_fma_f32 v[46:47], v[14:15], v[68:69], v[46:47] op_sel:[0,1,0] op_sel_hi:[1,1,1]
    v_pk_fma_f32 v[54:55], v[14:15], v[84:85], v[54:55] op_sel:[0,1,0] op_sel_hi:[1,1,1]
    v_lshlrev_b32 v8, 16, v160
    v_and_b32 v9, 0xffff0000, v160
    v_pk_fma_f32 v[40:41], v[8:9], v[70:71], v[40:41] op_sel:[0,0,0] op_sel_hi:[1,0,1]
    v_pk_fma_f32 v[48:49], v[8:9], v[86:87], v[48:49] op_sel:[0,0,0] op_sel_hi:[1,0,1]
    v_lshlrev_b32 v10, 16, v161
    v_and_b32 v11, 0xffff0000, v161
    v_pk_fma_f32 v[42:43], v[10:11], v[70:71], v[42:43] op_sel:[0,0,0] op_sel_hi:[1,0,1]
    v_pk_fma_f32 v[50:51], v[10:11], v[86:87], v[50:51] op_sel:[0,0,0] op_sel_hi:[1,0,1]
    v_lshlrev_b32 v12, 16, v162
    v_and_b32 v13, 0xffff0000, v162
    v_pk_fma_f32 v[44:45], v[12:13], v[70:71], v[44:45] op_sel:[0,0,0] op_sel_hi:[1,0,1]
    v_pk_fma_f32 v[52:53], v[12:13], v[86:87], v[52:53] op_sel:[0,0,0] op_sel_hi:[1,0,1]
    v_lshlrev_b32 v14, 16, v163
    v_and_b32 v15, 0xffff0000, v163
    v_pk_fma_f32 v[46:47], v[14:15], v[70:71], v[46:47] op_sel:[0,0,0] op_sel_hi:[1,0,1]
    v_pk_fma_f32 v[54:55], v[14:15], v[86:87], v[54:55] op_sel:[0,0,0] op_sel_hi:[1,0,1]
    v_lshlrev_b32 v8, 16, v164
    v_and_b32 v9, 0xffff0000, v164
    v_pk_fma_f32 v[40:41], v[8:9], v[70:71], v[40:41] op_sel:[0,1,0] op_sel_hi:[1,1,1]
    v_pk_fma_f32 v[48:49], v[8:9], v[86:87], v[48:49] op_sel:[0,1,0] op_sel_hi:[1,1,1]
    v_lshlrev_b32 v10, 16, v165
    v_and_b32 v11, 0xffff0000, v165
    v_pk_fma_f32 v[42:43], v[10:11], v[70:71], v[42:43] op_sel:[0,1,0] op_sel_hi:[1,1,1]
    v_pk_fma_f32 v[50:51], v[10:11], v[86:87], v[50:51] op_sel:[0,1,0] op_sel_hi:[1,1,1]
    v_lshlrev_b32 v12, 16, v166
    v_and_b32 v13, 0xffff0000, v166
    v_pk_fma_f32 v[44:45], v[12:13], v[70:71], v[44:45] op_sel:[0,1,0] op_sel_hi:[1,1,1]
    v_pk_fma_f32 v[52:53], v[12:13], v[86:87], v[52:53] op_sel:[0,1,0] op_sel_hi:[1,1,1]
    v_lshlrev_b32 v14, 16, v167
    v_and_b32 v15, 0xffff0000, v167
    v_pk_fma_f32 v[46:47], v[14:15], v[70:71], v[46:47] op_sel:[0,1,0] op_sel_hi:[1,1,1]
    v_pk_fma_f32 v[54:55], v[14:15], v[86:87], v[54:55] op_sel:[0,1,0] op_sel_hi:[1,1,1]
    s_nop 1
    v_permlane32_swap_b32 v40, v48
    v_permlane32_swap_b32 v41, v49
    v_permlane32_swap_b32 v42, v50
    v_permlane32_swap_b32 v43, v51
    v_permlane32_swap_b32 v44, v52
    v_permlane32_swap_b32 v45, v53
    v_permlane32_swap_b32 v46, v54
    v_permlane32_swap_b32 v47, v55
    s_nop 1
    v_add_f32 v40, v40, v48
    v_add_f32 v41, v41, v49
    v_add_f32 v42, v42, v50
    v_add_f32 v43, v43, v51
    v_add_f32 v44, v44, v52
    v_add_f32 v45, v45, v53
    v_add_f32 v46, v46, v54
    v_add_f32 v47, v47, v55
    s_nop 1
    v_permlane16_swap_b32 v40, v44
    v_permlane16_swap_b32 v41, v45
    v_permlane16_swap_b32 v42, v46
    v_permlane16_swap_b32 v43, v47
    s_nop 1
    v_add_f32 v40, v40, v44
    v_add_f32 v41, v41, v45
    v_add_f32 v42, v42, v46
    v_add_f32 v43, v43, v47
    s_nop 1
    v_add_f32 v40, v40, v40 row_ror:4 row_mask:0xf bank_mask:0xf
    v_add_f32 v41, v41, v41 row_ror:4 row_mask:0xf bank_mask:0xf
    v_add_f32 v42, v42, v42 row_ror:4 row_mask:0xf bank_mask:0xf
    v_add_f32 v43, v43, v43 row_ror:4 row_mask:0xf bank_mask:0xf
    s_nop 1
    v_add_f32 v40, v40, v40 row_ror:8 row_mask:0xf bank_mask:0xf
    v_add_f32 v41, v41, v41 row_ror:8 row_mask:0xf bank_mask:0xf
    v_add_f32 v42, v42, v42 row_ror:8 row_mask:0xf bank_mask:0xf
    v_add_f32 v43, v43, v43 row_ror:8 row_mask:0xf bank_mask:0xf
    s_nop 1
    v_add_f32 v40, v40, v40 quad_perm:[2,3,0,1] row_mask:0xf bank_mask:0xf
    v_add_f32 v41, v41, v41 quad_perm:[2,3,0,1] row_mask:0xf bank_mask:0xf
    v_add_f32 v42, v42, v42 quad_perm:[2,3,0,1] row_mask:0xf bank_mask:0xf
    v_add_f32 v43, v43, v43 quad_perm:[2,3,0,1] row_mask:0xf bank_mask:0xf
    s_mov_b32 exec_lo, 0x00030003
    s_mov_b32 exec_hi, 0x00030003
    ds_write_b128 v30, v[40:43] offset:6144
    s_mov_b64 exec, -1
    s_waitcnt lgkmcnt(0)
    v_bfe_u32 v8, v1, 4, 1
    v_lshlrev_b32 v8, 10, v8
    v_and_b32 v9, 15, v1
    v_lshl_add_u32 v8, v9, 2, v8
    ds_read_b32 v16, v8 offset:6400
    s_waitcnt lgkmcnt(0)
    v_cvt_pk_bf16_f32 v16, v16, v16
    v_and_b32 v16, 0xffff0000, v16
    v_max_f32 v16, 0, v16
    s_waitcnt vmcnt(0)
    v_readlane_b32 s50, v16, 0
    v_readlane_b32 s53, v16, 16
    v_lshlrev_b32 v8, 16, v168
    v_and_b32 v9, 0xffff0000, v168
    v_lshlrev_b32 v10, 16, v169
    v_and_b32 v11, 0xffff0000, v169
    v_lshlrev_b32 v12, 16, v170
    v_and_b32 v13, 0xffff0000, v170
    v_lshlrev_b32 v14, 16, v171
    v_and_b32 v15, 0xffff0000, v171
    v_mul_f32 v40, s50, v8
    v_mul_f32 v48, s53, v8
    v_mul_f32 v41, s50, v9
    v_mul_f32 v49, s53, v9
    v_mul_f32 v42, s50, v10
    v_mul_f32 v50, s53, v10
    v_mul_f32 v43, s50, v11
    v_mul_f32 v51, s53, v11
    v_mul_f32 v44, s50, v12
    v_mul_f32 v52, s53, v12
    v_mul_f32 v45, s50, v13
    v_mul_f32 v53, s53, v13
    v_mul_f32 v46, s50, v14
    v_mul_f32 v54, s53, v14
    v_mul_f32 v47, s50, v15
    v_mul_f32 v55, s53, v15
    v_readlane_b32 s50, v16, 1
    v_readlane_b32 s53, v16, 17
    v_lshlrev_b32 v8, 16, v172
    v_and_b32 v9, 0xffff0000, v172
    v_lshlrev_b32 v10, 16, v173
    v_and_b32 v11, 0xffff0000, v173
    v_lshlrev_b32 v12, 16, v174
    v_and_b32 v13, 0xffff0000, v174
    v_lshlrev_b32 v14, 16, v175
    v_and_b32 v15, 0xffff0000, v175
    v_fmac_f32 v40, s50, v8
    v_fmac_f32 v48, s53, v8
    v_fmac_f32 v41, s50, v9
    v_fmac_f32 v49, s53, v9
    v_fmac_f32 v42, s50, v10
    v_fmac_f32 v50, s53, v10
    v_fmac_f32 v43, s50, v11
    v_fmac_f32 v51, s53, v11
    v_fmac_f32 v44, s50, v12
    v_fmac_f32 v52, s53, v12
    v_fmac_f32 v45, s50, v13
    v_fmac_f32 v53, s53, v13
    v_fmac_f32 v46, s50, v14
    v_fmac_f32 v54, s53, v14
    v_fmac_f32 v47, s50, v15
    v_fmac_f32 v55, s53, v15
    v_readlane_b32 s50, v16, 2
    v_readlane_b32 s53, v16, 18
    v_lshlrev_b32 v8, 16, v176
    v_and_b32 v9, 0xffff0000, v176
    v_lshlrev_b32 v10, 16, v177
    v_and_b32 v11, 0xffff0000, v177
    v_lshlrev_b32 v12, 16, v178
    v_and_b32 v13, 0xffff0000, v178
    v_lshlrev_b32 v14, 16, v179
    v_and_b32 v15, 0xffff0000, v179
    v_fmac_f32 v40, s50, v8
    v_fmac_f32 v48, s53, v8
    v_fmac_f32 v41, s50, v9
    v_fmac_f32 v49, s53, v9
    v_fmac_f32 v42, s50, v10
    v_fmac_f32 v50, s53, v10
    v_fmac_f32 v43, s50, v11
    v_fmac_f32 v51, s53, v11
    v_fmac_f32 v44, s50, v12
    v_fmac_f32 v52, s53, v12
    v_fmac_f32 v45, s50, v13
    v_fmac_f32 v53, s53, v13
    v_fmac_f32 v46, s50, v14
    v_fmac_f32 v54, s53, v14
    v_fmac_f32 v47, s50, v15
    v_fmac_f32 v55, s53, v15
    v_readlane_b32 s50, v16, 3
    v_readlane_b32 s53, v16, 19
    v_lshlrev_b32 v8, 16, v180
    v_and_b32 v9, 0xffff0000, v180
    v_lshlrev_b32 v10, 16, v181
    v_and_b32 v11, 0xffff0000, v181
    v_lshlrev_b32 v12, 16, v182
    v_and_b32 v13, 0xffff0000, v182
    v_lshlrev_b32 v14, 16, v183
    v_and_b32 v15, 0xffff0000, v183
    v_fmac_f32 v40, s50, v8
    v_fmac_f32 v48, s53, v8
    v_fmac_f32 v41, s50, v9
    v_fmac_f32 v49, s53, v9
    v_fmac_f32 v42, s50, v10
    v_fmac_f32 v50, s53, v10
    v_fmac_f32 v43, s50, v11
    v_fmac_f32 v51, s53, v11
    v_fmac_f32 v44, s50, v12
    v_fmac_f32 v52, s53, v12
    v_fmac_f32 v45, s50, v13
    v_fmac_f32 v53, s53, v13
    v_fmac_f32 v46, s50, v14
    v_fmac_f32 v54, s53, v14
    v_fmac_f32 v47, s50, v15
    v_fmac_f32 v55, s53, v15
    v_readlane_b32 s50, v16, 4
    v_readlane_b32 s53, v16, 20
    v_lshlrev_b32 v8, 16, v184
    v_and_b32 v9, 0xffff0000, v184
    v_lshlrev_b32 v10, 16, v185
    v_and_b32 v11, 0xffff0000, v185
    v_lshlrev_b32 v12, 16, v186
    v_and_b32 v13, 0xffff0000, v186
    v_lshlrev_b32 v14, 16, v187
    v_and_b32 v15, 0xffff0000, v187
    v_fmac_f32 v40, s50, v8
    v_fmac_f32 v48, s53, v8
    v_fmac_f32 v41, s50, v9
    v_fmac_f32 v49, s53, v9
    v_fmac_f32 v42, s50, v10
    v_fmac_f32 v50, s53, v10
    v_fmac_f32 v43, s50, v11
    v_fmac_f32 v51, s53, v11
    v_fmac_f32 v44, s50, v12
    v_fmac_f32 v52, s53, v12
    v_fmac_f32 v45, s50, v13
    v_fmac_f32 v53, s53, v13
    v_fmac_f32 v46, s50, v14
    v_fmac_f32 v54, s53, v14
    v_fmac_f32 v47, s50, v15
    v_fmac_f32 v55, s53, v15
    v_readlane_b32 s50, v16, 5
    v_readlane_b32 s53, v16, 21
    v_lshlrev_b32 v8, 16, v188
    v_and_b32 v9, 0xffff0000, v188
    v_lshlrev_b32 v10, 16, v189
    v_and_b32 v11, 0xffff0000, v189
    v_lshlrev_b32 v12, 16, v190
    v_and_b32 v13, 0xffff0000, v190
    v_lshlrev_b32 v14, 16, v191
    v_and_b32 v15, 0xffff0000, v191
    v_fmac_f32 v40, s50, v8
    v_fmac_f32 v48, s53, v8
    v_fmac_f32 v41, s50, v9
    v_fmac_f32 v49, s53, v9
    v_fmac_f32 v42, s50, v10
    v_fmac_f32 v50, s53, v10
    v_fmac_f32 v43, s50, v11
    v_fmac_f32 v51, s53, v11
    v_fmac_f32 v44, s50, v12
    v_fmac_f32 v52, s53, v12
    v_fmac_f32 v45, s50, v13
    v_fmac_f32 v53, s53, v13
    v_fmac_f32 v46, s50, v14
    v_fmac_f32 v54, s53, v14
    v_fmac_f32 v47, s50, v15
    v_fmac_f32 v55, s53, v15
    v_readlane_b32 s50, v16, 6
    v_readlane_b32 s53, v16, 22
    v_lshlrev_b32 v8, 16, v192
    v_and_b32 v9, 0xffff0000, v192
    v_lshlrev_b32 v10, 16, v193
    v_and_b32 v11, 0xffff0000, v193
    v_lshlrev_b32 v12, 16, v194
    v_and_b32 v13, 0xffff0000, v194
    v_lshlrev_b32 v14, 16, v195
    v_and_b32 v15, 0xffff0000, v195
    v_fmac_f32 v40, s50, v8
    v_fmac_f32 v48, s53, v8
    v_fmac_f32 v41, s50, v9
    v_fmac_f32 v49, s53, v9
    v_fmac_f32 v42, s50, v10
    v_fmac_f32 v50, s53, v10
    v_fmac_f32 v43, s50, v11
    v_fmac_f32 v51, s53, v11
    v_fmac_f32 v44, s50, v12
    v_fmac_f32 v52, s53, v12
    v_fmac_f32 v45, s50, v13
    v_fmac_f32 v53, s53, v13
    v_fmac_f32 v46, s50, v14
    v_fmac_f32 v54, s53, v14
    v_fmac_f32 v47, s50, v15
    v_fmac_f32 v55, s53, v15
    v_readlane_b32 s50, v16, 7
    v_readlane_b32 s53, v16, 23
    v_lshlrev_b32 v8, 16, v196
    v_and_b32 v9, 0xffff0000, v196
    v_lshlrev_b32 v10, 16, v197
    v_and_b32 v11, 0xffff0000, v197
    v_lshlrev_b32 v12, 16, v198
    v_and_b32 v13, 0xffff0000, v198
    v_lshlrev_b32 v14, 16, v199
    v_and_b32 v15, 0xffff0000, v199
    v_fmac_f32 v40, s50, v8
    v_fmac_f32 v48, s53, v8
    v_fmac_f32 v41, s50, v9
    v_fmac_f32 v49, s53, v9
    v_fmac_f32 v42, s50, v10
    v_fmac_f32 v50, s53, v10
    v_fmac_f32 v43, s50, v11
    v_fmac_f32 v51, s53, v11
    v_fmac_f32 v44, s50, v12
    v_fmac_f32 v52, s53, v12
    v_fmac_f32 v45, s50, v13
    v_fmac_f32 v53, s53, v13
    v_fmac_f32 v46, s50, v14
    v_fmac_f32 v54, s53, v14
    v_fmac_f32 v47, s50, v15
    v_fmac_f32 v55, s53, v15
    v_readlane_b32 s50, v16, 8
    v_readlane_b32 s53, v16, 24
    v_lshlrev_b32 v8, 16, v200
    v_and_b32 v9, 0xffff0000, v200
    v_lshlrev_b32 v10, 16, v201
    v_and_b32 v11, 0xffff0000, v201
    v_lshlrev_b32 v12, 16, v202
    v_and_b32 v13, 0xffff0000, v202
    v_lshlrev_b32 v14, 16, v203
    v_and_b32 v15, 0xffff0000, v203
    v_fmac_f32 v40, s50, v8
    v_fmac_f32 v48, s53, v8
    v_fmac_f32 v41, s50, v9
    v_fmac_f32 v49, s53, v9
    v_fmac_f32 v42, s50, v10
    v_fmac_f32 v50, s53, v10
    v_fmac_f32 v43, s50, v11
    v_fmac_f32 v51, s53, v11
    v_fmac_f32 v44, s50, v12
    v_fmac_f32 v52, s53, v12
    v_fmac_f32 v45, s50, v13
    v_fmac_f32 v53, s53, v13
    v_fmac_f32 v46, s50, v14
    v_fmac_f32 v54, s53, v14
    v_fmac_f32 v47, s50, v15
    v_fmac_f32 v55, s53, v15
    v_readlane_b32 s50, v16, 9
    v_readlane_b32 s53, v16, 25
    v_lshlrev_b32 v8, 16, v204
    v_and_b32 v9, 0xffff0000, v204
    v_lshlrev_b32 v10, 16, v205
    v_and_b32 v11, 0xffff0000, v205
    v_lshlrev_b32 v12, 16, v206
    v_and_b32 v13, 0xffff0000, v206
    v_lshlrev_b32 v14, 16, v207
    v_and_b32 v15, 0xffff0000, v207
    v_fmac_f32 v40, s50, v8
    v_fmac_f32 v48, s53, v8
    v_fmac_f32 v41, s50, v9
    v_fmac_f32 v49, s53, v9
    v_fmac_f32 v42, s50, v10
    v_fmac_f32 v50, s53, v10
    v_fmac_f32 v43, s50, v11
    v_fmac_f32 v51, s53, v11
    v_fmac_f32 v44, s50, v12
    v_fmac_f32 v52, s53, v12
    v_fmac_f32 v45, s50, v13
    v_fmac_f32 v53, s53, v13
    v_fmac_f32 v46, s50, v14
    v_fmac_f32 v54, s53, v14
    v_fmac_f32 v47, s50, v15
    v_fmac_f32 v55, s53, v15
    v_readlane_b32 s50, v16, 10
    v_readlane_b32 s53, v16, 26
    v_lshlrev_b32 v8, 16, v208
    v_and_b32 v9, 0xffff0000, v208
    v_lshlrev_b32 v10, 16, v209
    v_and_b32 v11, 0xffff0000, v209
    v_lshlrev_b32 v12, 16, v210
    v_and_b32 v13, 0xffff0000, v210
    v_lshlrev_b32 v14, 16, v211
    v_and_b32 v15, 0xffff0000, v211
    v_fmac_f32 v40, s50, v8
    v_fmac_f32 v48, s53, v8
    v_fmac_f32 v41, s50, v9
    v_fmac_f32 v49, s53, v9
    v_fmac_f32 v42, s50, v10
    v_fmac_f32 v50, s53, v10
    v_fmac_f32 v43, s50, v11
    v_fmac_f32 v51, s53, v11
    v_fmac_f32 v44, s50, v12
    v_fmac_f32 v52, s53, v12
    v_fmac_f32 v45, s50, v13
    v_fmac_f32 v53, s53, v13
    v_fmac_f32 v46, s50, v14
    v_fmac_f32 v54, s53, v14
    v_fmac_f32 v47, s50, v15
    v_fmac_f32 v55, s53, v15
    v_readlane_b32 s50, v16, 11
    v_readlane_b32 s53, v16, 27
    v_lshlrev_b32 v8, 16, v212
    v_and_b32 v9, 0xffff0000, v212
    v_lshlrev_b32 v10, 16, v213
    v_and_b32 v11, 0xffff0000, v213
    v_lshlrev_b32 v12, 16, v214
    v_and_b32 v13, 0xffff0000, v214
    v_lshlrev_b32 v14, 16, v215
    v_and_b32 v15, 0xffff0000, v215
    v_fmac_f32 v40, s50, v8
    v_fmac_f32 v48, s53, v8
    v_fmac_f32 v41, s50, v9
    v_fmac_f32 v49, s53, v9
    v_fmac_f32 v42, s50, v10
    v_fmac_f32 v50, s53, v10
    v_fmac_f32 v43, s50, v11
    v_fmac_f32 v51, s53, v11
    v_fmac_f32 v44, s50, v12
    v_fmac_f32 v52, s53, v12
    v_fmac_f32 v45, s50, v13
    v_fmac_f32 v53, s53, v13
    v_fmac_f32 v46, s50, v14
    v_fmac_f32 v54, s53, v14
    v_fmac_f32 v47, s50, v15
    v_fmac_f32 v55, s53, v15
    v_readlane_b32 s50, v16, 12
    v_readlane_b32 s53, v16, 28
    v_lshlrev_b32 v8, 16, v216
    v_and_b32 v9, 0xffff0000, v216
    v_lshlrev_b32 v10, 16, v217
    v_and_b32 v11, 0xffff0000, v217
    v_lshlrev_b32 v12, 16, v218
    v_and_b32 v13, 0xffff0000, v218
    v_lshlrev_b32 v14, 16, v219
    v_and_b32 v15, 0xffff0000, v219
    v_fmac_f32 v40, s50, v8
    v_fmac_f32 v48, s53, v8
    v_fmac_f32 v41, s50, v9
    v_fmac_f32 v49, s53, v9
    v_fmac_f32 v42, s50, v10
    v_fmac_f32 v50, s53, v10
    v_fmac_f32 v43, s50, v11
    v_fmac_f32 v51, s53, v11
    v_fmac_f32 v44, s50, v12
    v_fmac_f32 v52, s53, v12
    v_fmac_f32 v45, s50, v13
    v_fmac_f32 v53, s53, v13
    v_fmac_f32 v46, s50, v14
    v_fmac_f32 v54, s53, v14
    v_fmac_f32 v47, s50, v15
    v_fmac_f32 v55, s53, v15
    v_readlane_b32 s50, v16, 13
    v_readlane_b32 s53, v16, 29
    v_lshlrev_b32 v8, 16, v220
    v_and_b32 v9, 0xffff0000, v220
    v_lshlrev_b32 v10, 16, v221
    v_and_b32 v11, 0xffff0000, v221
    v_lshlrev_b32 v12, 16, v222
    v_and_b32 v13, 0xffff0000, v222
    v_lshlrev_b32 v14, 16, v223
    v_and_b32 v15, 0xffff0000, v223
    v_fmac_f32 v40, s50, v8
    v_fmac_f32 v48, s53, v8
    v_fmac_f32 v41, s50, v9
    v_fmac_f32 v49, s53, v9
    v_fmac_f32 v42, s50, v10
    v_fmac_f32 v50, s53, v10
    v_fmac_f32 v43, s50, v11
    v_fmac_f32 v51, s53, v11
    v_fmac_f32 v44, s50, v12
    v_fmac_f32 v52, s53, v12
    v_fmac_f32 v45, s50, v13
    v_fmac_f32 v53, s53, v13
    v_fmac_f32 v46, s50, v14
    v_fmac_f32 v54, s53, v14
    v_fmac_f32 v47, s50, v15
    v_fmac_f32 v55, s53, v15
    v_readlane_b32 s50, v16, 14
    v_readlane_b32 s53, v16, 30
    v_lshlrev_b32 v8, 16, v224
    v_and_b32 v9, 0xffff0000, v224
    v_lshlrev_b32 v10, 16, v225
    v_and_b32 v11, 0xffff0000, v225
    v_lshlrev_b32 v12, 16, v226
    v_and_b32 v13, 0xffff0000, v226
    v_lshlrev_b32 v14, 16, v227
    v_and_b32 v15, 0xffff0000, v227
    v_fmac_f32 v40, s50, v8
    v_fmac_f32 v48, s53, v8
    v_fmac_f32 v41, s50, v9
    v_fmac_f32 v49, s53, v9
    v_fmac_f32 v42, s50, v10
    v_fmac_f32 v50, s53, v10
    v_fmac_f32 v43, s50, v11
    v_fmac_f32 v51, s53, v11
    v_fmac_f32 v44, s50, v12
    v_fmac_f32 v52, s53, v12
    v_fmac_f32 v45, s50, v13
    v_fmac_f32 v53, s53, v13
    v_fmac_f32 v46, s50, v14
    v_fmac_f32 v54, s53, v14
    v_fmac_f32 v47, s50, v15
    v_fmac_f32 v55, s53, v15
    v_readlane_b32 s50, v16, 15
    v_readlane_b32 s53, v16, 31
    v_lshlrev_b32 v8, 16, v228
    v_and_b32 v9, 0xffff0000, v228
    v_lshlrev_b32 v10, 16, v229
    v_and_b32 v11, 0xffff0000, v229
    v_lshlrev_b32 v12, 16, v230
    v_and_b32 v13, 0xffff0000, v230
    v_lshlrev_b32 v14, 16, v231
    v_and_b32 v15, 0xffff0000, v231
    v_fmac_f32 v40, s50, v8
    v_fmac_f32 v48, s53, v8
    v_fmac_f32 v41, s50, v9
    v_fmac_f32 v49, s53, v9
    v_fmac_f32 v42, s50, v10
    v_fmac_f32 v50, s53, v10
    v_fmac_f32 v43, s50, v11
    v_fmac_f32 v51, s53, v11
    v_fmac_f32 v44, s50, v12
    v_fmac_f32 v52, s53, v12
    v_fmac_f32 v45, s50, v13
    v_fmac_f32 v53, s53, v13
    v_fmac_f32 v46, s50, v14
    v_fmac_f32 v54, s53, v14
    v_fmac_f32 v47, s50, v15
    v_fmac_f32 v55, s53, v15
    v_lshlrev_b32 v10, 12, v1
    s_lshl_b32 s50, s2, 4
    s_add_u32 s50, s50, 0x180000
    s_add_u32 s53, s50, 0x40000
    buffer_store_dwordx4 v[40:43], v10, s[44:47], s50 offen sc0 sc1
    buffer_store_dwordx4 v[44:47], v10, s[44:47], s50 offen offset:2048 sc0 sc1
    buffer_store_dwordx4 v[48:51], v10, s[44:47], s53 offen sc0 sc1
    buffer_store_dwordx4 v[52:55], v10, s[44:47], s53 offen offset:2048 sc0 sc1
    s_branch L_PRE
L_CONS:
    s_lshl_b32 s51, s6, 3
    s_add_u32 s51, s51, s4
    s_lshl_b32 s7, s5, 26
    s_lshl_b32 s50, s4, 23
    s_add_u32 s7, s7, s50
    s_mul_i32 s50, s6, 393216
    s_sub_u32 s53, s6, 8
    s_mul_i32 s53, s53, 442368
    s_add_u32 s53, s53, 3145728
    s_cmp_lt_u32 s6, 8
    s_cselect_b32 s50, s50, s53
    s_mov_b32 s57, 57344
    s_mov_b32 s58, 69632
    s_cselect_b32 s57, s57, s58
    s_mov_b32 s58, 393216
    s_mov_b32 s53, 442368
    s_cselect_b32 s58, s58, s53
    s_add_u32 s7, s7, s50
    s_mul_i32 s50, s3, s57
    s_lshl_b32 s57, s57, 2
    s_sub_u32 s53, s3, 4
    s_mul_i32 s53, s53, 40960
    s_add_u32 s57, s57, s53
    s_cmp_lt_u32 s3, 4
    s_cselect_b32 s57, s50, s57
    s_mov_b32 s52, 0x3e0293ee
    v_and_b32 v12, 15, v1
    v_lshrrev_b32 v13, 4, v1
    v_and_b32 v14, 7, v12
    v_lshlrev_b32 v14, 8, v14
    v_lshrrev_b32 v15, 3, v12
    v_lshl_add_u32 v14, v15, 4, v14
    v_lshl_add_u32 v2, v13, 5, v14
    v_add_u32 v2, s57, v2
    v_lshlrev_b32 v3, 4, v12
    v_lshl_add_u32 v3, v13, 10, v3
    v_add_u32 v3, s57, v3
    v_and_b32 v14, 1, v12
    v_lshlrev_b32 v14, 4, v14
    v_mov_b32 v15, 0xffff
    v_lshlrev_b32 v15, v14, v15
    v_and_b32 v14, 2, v12
    v_cmp_eq_u32 vcc, 0, v14
    s_nop 1
    v_cndmask_b32 v4, 0, v15, vcc
    v_cndmask_b32 v5, v15, 0, vcc
    v_lshlrev_b32 v248, 2, v1
    s_mov_b32 s44, s84
    s_mov_b32 s45, s85
    s_mov_b32 s46, 0x300000
    s_mov_b32 s47, 0x00020000
    s_add_u32 s8, s66, s7
    s_addc_u32 s9, s67, 0
    s_mov_b32 s10, 0x80000
    s_mov_b32 s11, 0x00020000
    s_add_u32 s12, s68, s7
    s_addc_u32 s13, s69, 0
    s_mov_b32 s14, 0x80000
    s_mov_b32 s15, 0x00020000
    s_mov_b32 s10, s58
    s_mov_b32 s14, s58
    s_mov_b32 s40, s82
    s_mov_b32 s41, s83
    s_mov_b32 s42, 0x100
    s_mov_b32 s43, 0x00020000
    s_mov_b32 s20, s72
    s_mov_b32 s21, s73
    s_mov_b32 s22, 0x400000
    s_mov_b32 s23, 0x00020000
    s_mov_b32 s36, s80
    s_mov_b32 s37, s81
    s_mov_b32 s38, 0x800
    s_mov_b32 s39, 0x00020000
    s_cmp_lg_u32 s3, 4
    s_cbranch_scc1 L_PRE
    v_mov_b32 v12, -1
    v_mov_b32 v13, -1
    v_mov_b32 v14, -1
    v_mov_b32 v15, -1
    v_lshlrev_b32 v6, 4, v1
    s_mul_i32 s50, s2, 6144
    s_add_u32 s53, s50, 4096
    buffer_store_dwordx4 v[12:15], v6, s[44:47], s50 offen offset:0 sc0 sc1
    buffer_store_dwordx4 v[12:15], v6, s[44:47], s50 offen offset:1024 sc0 sc1
    buffer_store_dwordx4 v[12:15], v6, s[44:47], s50 offen offset:2048 sc0 sc1
    buffer_store_dwordx4 v[12:15], v6, s[44:47], s50 offen offset:3072 sc0 sc1
    buffer_store_dwordx4 v[12:15], v6, s[44:47], s53 offen offset:0 sc0 sc1
    buffer_store_dwordx4 v[12:15], v6, s[44:47], s53 offen offset:1024 sc0 sc1
L_PRE:
    s_mov_b32 s48, 0
    buffer_load_dwordx4 v[108:111], v2, s[8:11], s48 offen offset:0 nt
    buffer_load_dwordx4 v[112:115], v2, s[8:11], s48 offen offset:128 nt
    buffer_load_dwordx4 v[116:119], v2, s[8:11], s48 offen offset:2048 nt
    buffer_load_dwordx4 v[120:123], v2, s[8:11], s48 offen offset:2176 nt
    s_mov_b32 s48, 4096
    buffer_load_dwordx4 v[124:127], v2, s[8:11], s48 offen offset:0 nt
    buffer_load_dwordx4 v[128:131], v2, s[8:11], s48 offen offset:128 nt
    buffer_load_dwordx4 v[132:135], v2, s[8:11], s48 offen offset:2048 nt
    buffer_load_dwordx4 v[136:139], v2, s[8:11], s48 offen offset:2176 nt
    s_mov_b32 s48, 8192
    buffer_load_dwordx4 v[140:143], v2, s[8:11], s48 offen offset:0 nt
    buffer_load_dwordx4 v[144:147], v2, s[8:11], s48 offen offset:128 nt
    buffer_load_dwordx4 v[148:151], v2, s[8:11], s48 offen offset:2048 nt
    buffer_load_dwordx4 v[152:155], v2, s[8:11], s48 offen offset:2176 nt
    s_mov_b32 s48, 12288
    buffer_load_dwordx4 v[156:159], v2, s[8:11], s48 offen offset:0 nt
    buffer_load_dwordx4 v[160:163], v2, s[8:11], s48 offen offset:128 nt
    buffer_load_dwordx4 v[164:167], v2, s[8:11], s48 offen offset:2048 nt
    buffer_load_dwordx4 v[168:171], v2, s[8:11], s48 offen offset:2176 nt
    s_mov_b32 s48, 16384
    buffer_load_dwordx4 v[172:175], v2, s[8:11], s48 offen offset:0 nt
    buffer_load_dwordx4 v[176:179], v2, s[8:11], s48 offen offset:128 nt
    buffer_load_dwordx4 v[180:183], v2, s[8:11], s48 offen offset:2048 nt
    buffer_load_dwordx4 v[184:187], v2, s[8:11], s48 offen offset:2176 nt
    s_mov_b32 s48, 20480
    buffer_load_dwordx4 v[188:191], v2, s[8:11], s48 offen offset:0 nt
    buffer_load_dwordx4 v[192:195], v2, s[8:11], s48 offen offset:128 nt
    buffer_load_dwordx4 v[196:199], v2, s[8:11], s48 offen offset:2048 nt
    buffer_load_dwordx4 v[200:203], v2, s[8:11], s48 offen offset:2176 nt
    s_mov_b32 s48, 24576
    buffer_load_dwordx4 v[204:207], v2, s[8:11], s48 offen offset:0 nt
    buffer_load_dwordx4 v[208:211], v2, s[8:11], s48 offen offset:128 nt
    buffer_load_dwordx4 v[212:215], v2, s[8:11], s48 offen offset:2048 nt
    buffer_load_dwordx4 v[216:219], v2, s[8:11], s48 offen offset:2176 nt
    s_mov_b32 s48, 28672
    buffer_load_dwordx4 v[220:223], v2, s[8:11], s48 offen offset:0 nt
    buffer_load_dwordx4 v[224:227], v2, s[8:11], s48 offen offset:128 nt
    buffer_load_dwordx4 v[228:231], v2, s[8:11], s48 offen offset:2048 nt
    s_cmp_lg_u32 s3, 4
    s_cbranch_scc1 L_NFL
    s_waitcnt vmcnt(31)
    s_lshl_b32 s50, s60, 4
    s_add_u32 s50, s50, s6
    v_mov_b32 v12, 3
    v_mov_b32 v13, 0
    s_mov_b64 exec, 1
    buffer_store_byte v12, v13, s[40:43], s50 offen sc0 sc1
    s_mov_b64 exec, -1
L_NFL:
    s_cmp_lg_u32 s3, 5
    s_cbranch_scc1 L_BARC
    s_lshl_b32 s54, s6, 4
    s_add_u32 s54, s54, s60
    s_lshl_b32 s54, s54, 11
    s_add_u32 s54, s54, 0x240000
    v_lshlrev_b32 v6, 4, v1
    s_sub_u32 s50, s100, 2500
    s_subb_u32 s53, s101, 0
    v_mov_b32 v24, s50
    v_mov_b32 v25, s53
    s_mov_b32 s53, 262144
    s_mov_b32 s49, 0x4009c4
L_PLOOP:
    buffer_load_dwordx4 v[16:19], v6, s[44:47], s54 offen sc0 sc1
    buffer_load_dwordx4 v[20:23], v6, s[44:47], s54 offen offset:1024 sc0 sc1
    s_waitcnt vmcnt(1)
    v_sub_co_u32 v8, vcc, v18, v24
    v_subb_co_u32 v9, vcc, v19, v25, vcc
    v_min_u32 v9, 1, v9
    v_lshl_or_b32 v8, v9, 31, v8
    s_waitcnt vmcnt(0)
    v_sub_co_u32 v10, vcc, v22, v24
    v_subb_co_u32 v11, vcc, v23, v25, vcc
    v_min_u32 v11, 1, v11
    v_lshl_or_b32 v10, v11, 31, v10
    v_max_u32 v8, v8, v10
    v_cmp_le_u32 vcc, s49, v8
    s_cbranch_vccz L_QOK
    s_sub_u32 s53, s53, 1
    s_cmp_eq_u32 s53, 0
    s_cbranch_scc1 L_QOK
    s_sleep 1
    s_branch L_PLOOP
L_QOK:
    v_lshlrev_b32 v6, 3, v1
    ds_write_b64 v6, v[16:17] offset:49152
    ds_write_b64 v6, v[20:21] offset:49664
    s_waitcnt lgkmcnt(0)
L_BARC:
    s_barrier
L_AFTERQ:
    v_bfe_u32 v8, v1, 2, 2
    v_lshlrev_b32 v8, 8, v8
    v_lshrrev_b32 v9, 4, v1
    v_lshl_add_u32 v8, v9, 5, v8
    v_and_b32 v9, 1, v1
    v_lshl_add_u32 v8, v9, 4, v8
    ds_read_b128 v[16:19], v8 offset:49152
    ds_read_b128 v[20:23], v8 offset:49280
    s_waitcnt lgkmcnt(0)
    s_cmp_ge_u32 s3, 4
    s_cbranch_scc1 L_MAINB
    s_cmp_lt_u32 s6, 8
    s_cbranch_scc1 L_MAINP
    s_waitcnt vmcnt(27)
    v_mfma_f32_16x16x32_bf16 v[40:43], v[108:111], v[16:19], 0
    v_mfma_f32_16x16x32_bf16 v[24:27], v[116:119], v[16:19], 0
    v_mfma_f32_16x16x32_bf16 v[40:43], v[112:115], v[20:23], v[40:43]
    v_mfma_f32_16x16x32_bf16 v[24:27], v[120:123], v[20:23], v[24:27]
    buffer_load_dwordx4 v[108:111], v2, s[8:11], s48 offen offset:2176 nt
    s_mov_b32 s48, 32768
    buffer_load_dwordx4 v[112:115], v2, s[8:11], s48 offen offset:0 nt
    buffer_load_dwordx4 v[116:119], v2, s[8:11], s48 offen offset:128 nt
    buffer_load_dwordx4 v[120:123], v2, s[8:11], s48 offen offset:2048 nt
    s_waitcnt vmcnt(27)
    v_mfma_f32_16x16x32_bf16 v[44:47], v[124:127], v[16:19], 0
    v_mfma_f32_16x16x32_bf16 v[28:31], v[132:135], v[16:19], 0
    v_mfma_f32_16x16x32_bf16 v[44:47], v[128:131], v[20:23], v[44:47]
    v_mfma_f32_16x16x32_bf16 v[28:31], v[136:139], v[20:23], v[28:31]
    buffer_load_dwordx4 v[124:127], v2, s[8:11], s48 offen offset:2176 nt
    s_mov_b32 s48, 36864
    buffer_load_dwordx4 v[128:131], v2, s[8:11], s48 offen offset:0 nt
    buffer_load_dwordx4 v[132:135], v2, s[8:11], s48 offen offset:128 nt
    buffer_load_dwordx4 v[136:139], v2, s[8:11], s48 offen offset:2048 nt
    s_nop 3
    v_permlane32_swap_b32 v40, v24
    v_permlane32_swap_b32 v41, v25
    v_permlane32_swap_b32 v42, v26
    v_permlane32_swap_b32 v43, v27
    s_nop 1
    v_mov_b32 v8, v40 quad_perm:[0,0,2,2] row_mask:0xf bank_mask:0xf
    v_mov_b32 v9, v41 quad_perm:[0,0,2,2] row_mask:0xf bank_mask:0xf
    v_mov_b32 v10, v42 quad_perm:[0,0,2,2] row_mask:0xf bank_mask:0xf
    v_mov_b32 v11, v43 quad_perm:[0,0,2,2] row_mask:0xf bank_mask:0xf
    v_add_f32 v40, v24, v8 quad_perm:[1,1,3,3] row_mask:0xf bank_mask:0xf
    v_add_f32 v41, v25, v9 quad_perm:[1,1,3,3] row_mask:0xf bank_mask:0xf
    v_add_f32 v42, v26, v10 quad_perm:[1,1,3,3] row_mask:0xf bank_mask:0xf
    v_add_f32 v43, v27, v11 quad_perm:[1,1,3,3] row_mask:0xf bank_mask:0xf
    s_waitcnt vmcnt(27)
    v_mfma_f32_16x16x32_bf16 v[48:51], v[140:143], v[16:19], 0
    v_mfma_f32_16x16x32_bf16 v[24:27], v[148:151], v[16:19], 0
    v_mfma_f32_16x16x32_bf16 v[48:51], v[144:147], v[20:23], v[48:51]
    v_mfma_f32_16x16x32_bf16 v[24:27], v[152:155], v[20:23], v[24:27]
    buffer_load_dwordx4 v[140:143], v2, s[8:11], s48 offen offset:2176 nt
    s_mov_b32 s48, 40960
    buffer_load_dwordx4 v[144:147], v2, s[8:11], s48 offen offset:0 nt
    buffer_load_dwordx4 v[148:151], v2, s[8:11], s48 offen offset:128 nt
    buffer_load_dwordx4 v[152:155], v2, s[8:11], s48 offen offset:2048 nt
    s_nop 3
    v_permlane32_swap_b32 v44, v28
    v_permlane32_swap_b32 v45, v29
    v_permlane32_swap_b32 v46, v30
    v_permlane32_swap_b32 v47, v31
    s_nop 1
    v_mov_b32 v8, v44 quad_perm:[0,0,2,2] row_mask:0xf bank_mask:0xf
    v_mov_b32 v9, v45 quad_perm:[0,0,2,2] row_mask:0xf bank_mask:0xf
    v_mov_b32 v10, v46 quad_perm:[0,0,2,2] row_mask:0xf bank_mask:0xf
    v_mov_b32 v11, v47 quad_perm:[0,0,2,2] row_mask:0xf bank_mask:0xf
    v_add_f32 v44, v28, v8 quad_perm:[1,1,3,3] row_mask:0xf bank_mask:0xf
    v_add_f32 v45, v29, v9 quad_perm:[1,1,3,3] row_mask:0xf bank_mask:0xf
    v_add_f32 v46, v30, v10 quad_perm:[1,1,3,3] row_mask:0xf bank_mask:0xf
    v_add_f32 v47, v31, v11 quad_perm:[1,1,3,3] row_mask:0xf bank_mask:0xf
    s_waitcnt vmcnt(27)
    v_mfma_f32_16x16x32_bf16 v[52:55], v[156:159], v[16:19], 0
    v_mfma_f32_16x16x32_bf16 v[28:31], v[164:167], v[16:19], 0
    v_mfma_f32_16x16x32_bf16 v[52:55], v[160:163], v[20:23], v[52:55]
    v_mfma_f32_16x16x32_bf16 v[28:31], v[168:171], v[20:23], v[28:31]
    buffer_load_dwordx4 v[156:159], v2, s[8:11], s48 offen offset:2176 nt
    s_mov_b32 s48, 45056
    buffer_load_dwordx4 v[160:163], v2, s[8:11], s48 offen offset:0 nt
    buffer_load_dwordx4 v[164:167], v2, s[8:11], s48 offen offset:128 nt
    buffer_load_dwordx4 v[168:171], v2, s[8:11], s48 offen offset:2048 nt
    s_nop 3
    v_permlane32_swap_b32 v48, v24
    v_permlane32_swap_b32 v49, v25
    v_permlane32_swap_b32 v50, v26
    v_permlane32_swap_b32 v51, v27
    s_nop 1
    v_mov_b32 v8, v48 quad_perm:[0,0,2,2] row_mask:0xf bank_mask:0xf
    v_mov_b32 v9, v49 quad_perm:[0,0,2,2] row_mask:0xf bank_mask:0xf
    v_mov_b32 v10, v50 quad_perm:[0,0,2,2] row_mask:0xf bank_mask:0xf
    v_mov_b32 v11, v51 quad_perm:[0,0,2,2] row_mask:0xf bank_mask:0xf
    v_add_f32 v48, v24, v8 quad_perm:[1,1,3,3] row_mask:0xf bank_mask:0xf
    v_add_f32 v49, v25, v9 quad_perm:[1,1,3,3] row_mask:0xf bank_mask:0xf
    v_add_f32 v50, v26, v10 quad_perm:[1,1,3,3] row_mask:0xf bank_mask:0xf
    v_add_f32 v51, v27, v11 quad_perm:[1,1,3,3] row_mask:0xf bank_mask:0xf
    s_waitcnt vmcnt(27)
    v_mfma_f32_16x16x32_bf16 v[56:59], v[172:175], v[16:19], 0
    v_mfma_f32_16x16x32_bf16 v[24:27], v[180:183], v[16:19], 0
    v_mfma_f32_16x16x32_bf16 v[56:59], v[176:179], v[20:23], v[56:59]
    v_mfma_f32_16x16x32_bf16 v[24:27], v[184:187], v[20:23], v[24:27]
    buffer_load_dwordx4 v[172:175], v2, s[8:11], s48 offen offset:2176 nt
    s_mov_b32 s48, 49152
    buffer_load_dwordx4 v[176:179], v2, s[8:11], s48 offen offset:0 nt
    buffer_load_dwordx4 v[180:183], v2, s[8:11], s48 offen offset:128 nt
    buffer_load_dwordx4 v[184:187], v2, s[8:11], s48 offen offset:2048 nt
    s_nop 3
    v_permlane32_swap_b32 v52, v28
    v_permlane32_swap_b32 v53, v29
    v_permlane32_swap_b32 v54, v30
    v_permlane32_swap_b32 v55, v31
    s_nop 1
    v_mov_b32 v8, v52 quad_perm:[0,0,2,2] row_mask:0xf bank_mask:0xf
    v_mov_b32 v9, v53 quad_perm:[0,0,2,2] row_mask:0xf bank_mask:0xf
    v_mov_b32 v10, v54 quad_perm:[0,0,2,2] row_mask:0xf bank_mask:0xf
    v_mov_b32 v11, v55 quad_perm:[0,0,2,2] row_mask:0xf bank_mask:0xf
    v_add_f32 v52, v28, v8 quad_perm:[1,1,3,3] row_mask:0xf bank_mask:0xf
    v_add_f32 v53, v29, v9 quad_perm:[1,1,3,3] row_mask:0xf bank_mask:0xf
    v_add_f32 v54, v30, v10 quad_perm:[1,1,3,3] row_mask:0xf bank_mask:0xf
    v_add_f32 v55, v31, v11 quad_perm:[1,1,3,3] row_mask:0xf bank_mask:0xf
    s_waitcnt vmcnt(27)
    v_mfma_f32_16x16x32_bf16 v[60:63], v[188:191], v[16:19], 0
    v_mfma_f32_16x16x32_bf16 v[28:31], v[196:199], v[16:19], 0
    v_mfma_f32_16x16x32_bf16 v[60:63], v[192:195], v[20:23], v[60:63]
    v_mfma_f32_16x16x32_bf16 v[28:31], v[200:203], v[20:23], v[28:31]
    buffer_load_dwordx4 v[188:191], v2, s[8:11], s48 offen offset:2176 nt
    s_mov_b32 s48, 53248
    buffer_load_dwordx4 v[192:195], v2, s[8:11], s48 offen offset:0 nt
    buffer_load_dwordx4 v[196:199], v2, s[8:11], s48 offen offset:128 nt
    buffer_load_dwordx4 v[200:203], v2, s[8:11], s48 offen offset:2048 nt
    s_nop 3
    v_permlane32_swap_b32 v56, v24
    v_permlane32_swap_b32 v57, v25
    v_permlane32_swap_b32 v58, v26
    v_permlane32_swap_b32 v59, v27
    s_nop 1
    v_mov_b32 v8, v56 quad_perm:[0,0,2,2] row_mask:0xf bank_mask:0xf
    v_mov_b32 v9, v57 quad_perm:[0,0,2,2] row_mask:0xf bank_mask:0xf
    v_mov_b32 v10, v58 quad_perm:[0,0,2,2] row_mask:0xf bank_mask:0xf
    v_mov_b32 v11, v59 quad_perm:[0,0,2,2] row_mask:0xf bank_mask:0xf
    v_add_f32 v56, v24, v8 quad_perm:[1,1,3,3] row_mask:0xf bank_mask:0xf
    v_add_f32 v57, v25, v9 quad_perm:[1,1,3,3] row_mask:0xf bank_mask:0xf
    v_add_f32 v58, v26, v10 quad_perm:[1,1,3,3] row_mask:0xf bank_mask:0xf
    v_add_f32 v59, v27, v11 quad_perm:[1,1,3,3] row_mask:0xf bank_mask:0xf
    s_waitcnt vmcnt(27)
    v_mfma_f32_16x16x32_bf16 v[64:67], v[204:207], v[16:19], 0
    v_mfma_f32_16x16x32_bf16 v[24:27], v[212:215], v[16:19], 0
    v_mfma_f32_16x16x32_bf16 v[64:67], v[208:211], v[20:23], v[64:67]
    v_mfma_f32_16x16x32_bf16 v[24:27], v[216:219], v[20:23], v[24:27]
    buffer_load_dwordx4 v[204:207], v2, s[8:11], s48 offen offset:2176 nt
    s_mov_b32 s48, 57344
    buffer_load_dwordx4 v[208:211], v2, s[8:11], s48 offen offset:0 nt
    buffer_load_dwordx4 v[212:215], v2, s[8:11], s48 offen offset:128 nt
    buffer_load_dwordx4 v[216:219], v2, s[8:11], s48 offen offset:2048 nt
    s_nop 3
    v_permlane32_swap_b32 v60, v28
    v_permlane32_swap_b32 v61, v29
    v_permlane32_swap_b32 v62, v30
    v_permlane32_swap_b32 v63, v31
    s_nop 1
    v_mov_b32 v8, v60 quad_perm:[0,0,2,2] row_mask:0xf bank_mask:0xf
    v_mov_b32 v9, v61 quad_perm:[0,0,2,2] row_mask:0xf bank_mask:0xf
    v_mov_b32 v10, v62 quad_perm:[0,0,2,2] row_mask:0xf bank_mask:0xf
    v_mov_b32 v11, v63 quad_perm:[0,0,2,2] row_mask:0xf bank_mask:0xf
    v_add_f32 v60, v28, v8 quad_perm:[1,1,3,3] row_mask:0xf bank_mask:0xf
    v_add_f32 v61, v29, v9 quad_perm:[1,1,3,3] row_mask:0xf bank_mask:0xf
    v_add_f32 v62, v30, v10 quad_perm:[1,1,3,3] row_mask:0xf bank_mask:0xf
    v_add_f32 v63, v31, v11 quad_perm:[1,1,3,3] row_mask:0xf bank_mask:0xf
    s_waitcnt vmcnt(27)
    v_mfma_f32_16x16x32_bf16 v[68:71], v[220:223], v[16:19], 0
    v_mfma_f32_16x16x32_bf16 v[28:31], v[228:231], v[16:19], 0
    v_mfma_f32_16x16x32_bf16 v[68:71], v[224:227], v[20:23], v[68:71]
    v_mfma_f32_16x16x32_bf16 v[28:31], v[108:111], v[20:23], v[28:31]
    buffer_load_dwordx4 v[220:223], v2, s[8:11], s48 offen offset:2176 nt
    s_mov_b32 s48, 61440
    buffer_load_dwordx4 v[224:227], v2, s[8:11], s48 offen offset:0 nt
    buffer_load_dwordx4 v[228:231], v2, s[8:11], s48 offen offset:128 nt
    buffer_load_dwordx4 v[108:111], v2, s[8:11], s48 offen offset:2048 nt
    s_nop 3
    v_permlane32_swap_b32 v64, v24
    v_permlane32_swap_b32 v65, v25
    v_permlane32_swap_b32 v66, v26
    v_permlane32_swap_b32 v67, v27
    s_nop 1
    v_mov_b32 v8, v64 quad_perm:[0,0,2,2] row_mask:0xf bank_mask:0xf
    v_mov_b32 v9, v65 quad_perm:[0,0,2,2] row_mask:0xf bank_mask:0xf
    v_mov_b32 v10, v66 quad_perm:[0,0,2,2] row_mask:0xf bank_mask:0xf
    v_mov_b32 v11, v67 quad_perm:[0,0,2,2] row_mask:0xf bank_mask:0xf
    v_add_f32 v64, v24, v8 quad_perm:[1,1,3,3] row_mask:0xf bank_mask:0xf
    v_add_f32 v65, v25, v9 quad_perm:[1,1,3,3] row_mask:0xf bank_mask:0xf
    v_add_f32 v66, v26, v10 quad_perm:[1,1,3,3] row_mask:0xf bank_mask:0xf
    v_add_f32 v67, v27, v11 quad_perm:[1,1,3,3] row_mask:0xf bank_mask:0xf
    s_waitcnt vmcnt(27)
    v_mfma_f32_16x16x32_bf16 v[72:75], v[112:115], v[16:19], 0
    v_mfma_f32_16x16x32_bf16 v[24:27], v[120:123], v[16:19], 0
    v_mfma_f32_16x16x32_bf16 v[72:75], v[116:119], v[20:23], v[72:75]
    v_mfma_f32_16x16x32_bf16 v[24:27], v[124:127], v[20:23], v[24:27]
    buffer_load_dwordx4 v[112:115], v2, s[8:11], s48 offen offset:2176 nt
    s_mov_b32 s48, 65536
    buffer_load_dwordx4 v[116:119], v2, s[8:11], s48 offen offset:0 nt
    buffer_load_dwordx4 v[120:123], v2, s[8:11], s48 offen offset:128 nt
    buffer_load_dwordx4 v[124:127], v2, s[8:11], s48 offen offset:2048 nt
    s_nop 3
    v_permlane32_swap_b32 v68, v28
    v_permlane32_swap_b32 v69, v29
    v_permlane32_swap_b32 v70, v30
    v_permlane32_swap_b32 v71, v31
    s_nop 1
    v_mov_b32 v8, v68 quad_perm:[0,0,2,2] row_mask:0xf bank_mask:0xf
    v_mov_b32 v9, v69 quad_perm:[0,0,2,2] row_mask:0xf bank_mask:0xf
    v_mov_b32 v10, v70 quad_perm:[0,0,2,2] row_mask:0xf bank_mask:0xf
    v_mov_b32 v11, v71 quad_perm:[0,0,2,2] row_mask:0xf bank_mask:0xf
    v_add_f32 v68, v28, v8 quad_perm:[1,1,3,3] row_mask:0xf bank_mask:0xf
    v_add_f32 v69, v29, v9 quad_perm:[1,1,3,3] row_mask:0xf bank_mask:0xf
    v_add_f32 v70, v30, v10 quad_perm:[1,1,3,3] row_mask:0xf bank_mask:0xf
    v_add_f32 v71, v31, v11 quad_perm:[1,1,3,3] row_mask:0xf bank_mask:0xf
    s_waitcnt vmcnt(27)
    v_mfma_f32_16x16x32_bf16 v[76:79], v[128:131], v[16:19], 0
    v_mfma_f32_16x16x32_bf16 v[28:31], v[136:139], v[16:19], 0
    v_mfma_f32_16x16x32_bf16 v[76:79], v[132:135], v[20:23], v[76:79]
    v_mfma_f32_16x16x32_bf16 v[28:31], v[140:143], v[20:23], v[28:31]
    buffer_load_dwordx4 v[128:131], v2, s[8:11], s48 offen offset:2176 nt
    s_mov_b32 s49, 0
    buffer_load_dwordx4 v[132:135], v3, s[12:15], s49 offen offset:0 nt
    buffer_load_dwordx4 v[136:139], v3, s[12:15], s49 offen offset:256 nt
    buffer_load_dwordx4 v[140:143], v3, s[12:15], s49 offen offset:512 nt
    s_nop 3
    v_permlane32_swap_b32 v72, v24
    v_permlane32_swap_b32 v73, v25
    v_permlane32_swap_b32 v74, v26
    v_permlane32_swap_b32 v75, v27
    s_nop 1
    v_mov_b32 v8, v72 quad_perm:[0,0,2,2] row_mask:0xf bank_mask:0xf
    v_mov_b32 v9, v73 quad_perm:[0,0,2,2] row_mask:0xf bank_mask:0xf
    v_mov_b32 v10, v74 quad_perm:[0,0,2,2] row_mask:0xf bank_mask:0xf
    v_mov_b32 v11, v75 quad_perm:[0,0,2,2] row_mask:0xf bank_mask:0xf
    v_add_f32 v72, v24, v8 quad_perm:[1,1,3,3] row_mask:0xf bank_mask:0xf
    v_add_f32 v73, v25, v9 quad_perm:[1,1,3,3] row_mask:0xf bank_mask:0xf
    v_add_f32 v74, v26, v10 quad_perm:[1,1,3,3] row_mask:0xf bank_mask:0xf
    v_add_f32 v75, v27, v11 quad_perm:[1,1,3,3] row_mask:0xf bank_mask:0xf
    s_waitcnt vmcnt(27)
    v_mfma_f32_16x16x32_bf16 v[80:83], v[144:147], v[16:19], 0
    v_mfma_f32_16x16x32_bf16 v[24:27], v[152:155], v[16:19], 0
    v_mfma_f32_16x16x32_bf16 v[80:83], v[148:151], v[20:23], v[80:83]
    v_mfma_f32_16x16x32_bf16 v[24:27], v[156:159], v[20:23], v[24:27]
    buffer_load_dwordx4 v[144:147], v3, s[12:15], s49 offen offset:768 nt
    s_mov_b32 s49, 4096
    buffer_load_dwordx4 v[148:151], v3, s[12:15], s49 offen offset:0 nt
    buffer_load_dwordx4 v[152:155], v3, s[12:15], s49 offen offset:256 nt
    buffer_load_dwordx4 v[156:159], v3, s[12:15], s49 offen offset:512 nt
    s_nop 3
    v_permlane32_swap_b32 v76, v28
    v_permlane32_swap_b32 v77, v29
    v_permlane32_swap_b32 v78, v30
    v_permlane32_swap_b32 v79, v31
    s_nop 1
    v_mov_b32 v8, v76 quad_perm:[0,0,2,2] row_mask:0xf bank_mask:0xf
    v_mov_b32 v9, v77 quad_perm:[0,0,2,2] row_mask:0xf bank_mask:0xf
    v_mov_b32 v10, v78 quad_perm:[0,0,2,2] row_mask:0xf bank_mask:0xf
    v_mov_b32 v11, v79 quad_perm:[0,0,2,2] row_mask:0xf bank_mask:0xf
    v_add_f32 v76, v28, v8 quad_perm:[1,1,3,3] row_mask:0xf bank_mask:0xf
    v_add_f32 v77, v29, v9 quad_perm:[1,1,3,3] row_mask:0xf bank_mask:0xf
    v_add_f32 v78, v30, v10 quad_perm:[1,1,3,3] row_mask:0xf bank_mask:0xf
    v_add_f32 v79, v31, v11 quad_perm:[1,1,3,3] row_mask:0xf bank_mask:0xf
    s_waitcnt vmcnt(27)
    v_mfma_f32_16x16x32_bf16 v[84:87], v[160:163], v[16:19], 0
    v_mfma_f32_16x16x32_bf16 v[28:31], v[168:171], v[16:19], 0
    v_mfma_f32_16x16x32_bf16 v[84:87], v[164:167], v[20:23], v[84:87]
    v_mfma_f32_16x16x32_bf16 v[28:31], v[172:175], v[20:23], v[28:31]
    buffer_load_dwordx4 v[160:163], v3, s[12:15], s49 offen offset:768 nt
    s_mov_b32 s49, 8192
    buffer_load_dwordx4 v[164:167], v3, s[12:15], s49 offen offset:0 nt
    buffer_load_dwordx4 v[168:171], v3, s[12:15], s49 offen offset:256 nt
    buffer_load_dwordx4 v[172:175], v3, s[12:15], s49 offen offset:512 nt
    s_nop 3
    v_permlane32_swap_b32 v80, v24
    v_permlane32_swap_b32 v81, v25
    v_permlane32_swap_b32 v82, v26
    v_permlane32_swap_b32 v83, v27
    s_nop 1
    v_mov_b32 v8, v80 quad_perm:[0,0,2,2] row_mask:0xf bank_mask:0xf
    v_mov_b32 v9, v81 quad_perm:[0,0,2,2] row_mask:0xf bank_mask:0xf
    v_mov_b32 v10, v82 quad_perm:[0,0,2,2] row_mask:0xf bank_mask:0xf
    v_mov_b32 v11, v83 quad_perm:[0,0,2,2] row_mask:0xf bank_mask:0xf
    v_add_f32 v80, v24, v8 quad_perm:[1,1,3,3] row_mask:0xf bank_mask:0xf
    v_add_f32 v81, v25, v9 quad_perm:[1,1,3,3] row_mask:0xf bank_mask:0xf
    v_add_f32 v82, v26, v10 quad_perm:[1,1,3,3] row_mask:0xf bank_mask:0xf
    v_add_f32 v83, v27, v11 quad_perm:[1,1,3,3] row_mask:0xf bank_mask:0xf
    s_waitcnt vmcnt(27)
    v_mfma_f32_16x16x32_bf16 v[88:91], v[176:179], v[16:19], 0
    v_mfma_f32_16x16x32_bf16 v[24:27], v[184:187], v[16:19], 0
    v_mfma_f32_16x16x32_bf16 v[88:91], v[180:183], v[20:23], v[88:91]
    v_mfma_f32_16x16x32_bf16 v[24:27], v[188:191], v[20:23], v[24:27]
    buffer_load_dwordx4 v[176:179], v3, s[12:15], s49 offen offset:768 nt
    s_mov_b32 s49, 12288
    buffer_load_dwordx4 v[180:183], v3, s[12:15], s49 offen offset:0 nt
    buffer_load_dwordx4 v[184:187], v3, s[12:15], s49 offen offset:256 nt
    buffer_load_dwordx4 v[188:191], v3, s[12:15], s49 offen offset:512 nt
    s_nop 3
    v_permlane32_swap_b32 v84, v28
    v_permlane32_swap_b32 v85, v29
    v_permlane32_swap_b32 v86, v30
    v_permlane32_swap_b32 v87, v31
    s_nop 1
    v_mov_b32 v8, v84 quad_perm:[0,0,2,2] row_mask:0xf bank_mask:0xf
    v_mov_b32 v9, v85 quad_perm:[0,0,2,2] row_mask:0xf bank_mask:0xf
    v_mov_b32 v10, v86 quad_perm:[0,0,2,2] row_mask:0xf bank_mask:0xf
    v_mov_b32 v11, v87 quad_perm:[0,0,2,2] row_mask:0xf bank_mask:0xf
    v_add_f32 v84, v28, v8 quad_perm:[1,1,3,3] row_mask:0xf bank_mask:0xf
    v_add_f32 v85, v29, v9 quad_perm:[1,1,3,3] row_mask:0xf bank_mask:0xf
    v_add_f32 v86, v30, v10 quad_perm:[1,1,3,3] row_mask:0xf bank_mask:0xf
    v_add_f32 v87, v31, v11 quad_perm:[1,1,3,3] row_mask:0xf bank_mask:0xf
    s_waitcnt vmcnt(27)
    v_mfma_f32_16x16x32_bf16 v[92:95], v[192:195], v[16:19], 0
    v_mfma_f32_16x16x32_bf16 v[28:31], v[200:203], v[16:19], 0
    v_mfma_f32_16x16x32_bf16 v[92:95], v[196:199], v[20:23], v[92:95]
    v_mfma_f32_16x16x32_bf16 v[28:31], v[204:207], v[20:23], v[28:31]
    buffer_load_dwordx4 v[192:195], v3, s[12:15], s49 offen offset:768 nt
    s_mov_b32 s49, 16384
    buffer_load_dwordx4 v[196:199], v3, s[12:15], s49 offen offset:0 nt
    buffer_load_dwordx4 v[200:203], v3, s[12:15], s49 offen offset:256 nt
    buffer_load_dwordx4 v[204:207], v3, s[12:15], s49 offen offset:512 nt
    s_nop 3
    v_permlane32_swap_b32 v88, v24
    v_permlane32_swap_b32 v89, v25
    v_permlane32_swap_b32 v90, v26
    v_permlane32_swap_b32 v91, v27
    s_nop 1
    v_mov_b32 v8, v88 quad_perm:[0,0,2,2] row_mask:0xf bank_mask:0xf
    v_mov_b32 v9, v89 quad_perm:[0,0,2,2] row_mask:0xf bank_mask:0xf
    v_mov_b32 v10, v90 quad_perm:[0,0,2,2] row_mask:0xf bank_mask:0xf
    v_mov_b32 v11, v91 quad_perm:[0,0,2,2] row_mask:0xf bank_mask:0xf
    v_add_f32 v88, v24, v8 quad_perm:[1,1,3,3] row_mask:0xf bank_mask:0xf
    v_add_f32 v89, v25, v9 quad_perm:[1,1,3,3] row_mask:0xf bank_mask:0xf
    v_add_f32 v90, v26, v10 quad_perm:[1,1,3,3] row_mask:0xf bank_mask:0xf
    v_add_f32 v91, v27, v11 quad_perm:[1,1,3,3] row_mask:0xf bank_mask:0xf
    s_waitcnt vmcnt(27)
    v_mfma_f32_16x16x32_bf16 v[96:99], v[208:211], v[16:19], 0
    v_mfma_f32_16x16x32_bf16 v[24:27], v[216:219], v[16:19], 0
    v_mfma_f32_16x16x32_bf16 v[96:99], v[212:215], v[20:23], v[96:99]
    v_mfma_f32_16x16x32_bf16 v[24:27], v[220:223], v[20:23], v[24:27]
    buffer_load_dwordx4 v[208:211], v3, s[12:15], s49 offen offset:768 nt
    s_mov_b32 s49, 20480
    buffer_load_dwordx4 v[212:215], v3, s[12:15], s49 offen offset:0 nt
    buffer_load_dwordx4 v[216:219], v3, s[12:15], s49 offen offset:256 nt
    buffer_load_dwordx4 v[220:223], v3, s[12:15], s49 offen offset:512 nt
    s_nop 3
    v_permlane32_swap_b32 v92, v28
    v_permlane32_swap_b32 v93, v29
    v_permlane32_swap_b32 v94, v30
    v_permlane32_swap_b32 v95, v31
    s_nop 1
    v_mov_b32 v8, v92 quad_perm:[0,0,2,2] row_mask:0xf bank_mask:0xf
    v_mov_b32 v9, v93 quad_perm:[0,0,2,2] row_mask:0xf bank_mask:0xf
    v_mov_b32 v10, v94 quad_perm:[0,0,2,2] row_mask:0xf bank_mask:0xf
    v_mov_b32 v11, v95 quad_perm:[0,0,2,2] row_mask:0xf bank_mask:0xf
    v_add_f32 v92, v28, v8 quad_perm:[1,1,3,3] row_mask:0xf bank_mask:0xf
    v_add_f32 v93, v29, v9 quad_perm:[1,1,3,3] row_mask:0xf bank_mask:0xf
    v_add_f32 v94, v30, v10 quad_perm:[1,1,3,3] row_mask:0xf bank_mask:0xf
    v_add_f32 v95, v31, v11 quad_perm:[1,1,3,3] row_mask:0xf bank_mask:0xf
    s_waitcnt vmcnt(27)
    v_mfma_f32_16x16x32_bf16 v[100:103], v[224:227], v[16:19], 0
    v_mfma_f32_16x16x32_bf16 v[28:31], v[108:111], v[16:19], 0
    v_mfma_f32_16x16x32_bf16 v[100:103], v[228:231], v[20:23], v[100:103]
    v_mfma_f32_16x16x32_bf16 v[28:31], v[112:115], v[20:23], v[28:31]
    buffer_load_dwordx4 v[224:227], v3, s[12:15], s49 offen offset:768 nt
    s_mov_b32 s49, 24576
    buffer_load_dwordx4 v[228:231], v3, s[12:15], s49 offen offset:0 nt
    buffer_load_dwordx4 v[108:111], v3, s[12:15], s49 offen offset:256 nt
    buffer_load_dwordx4 v[112:115], v3, s[12:15], s49 offen offset:512 nt
    s_nop 3
    v_permlane32_swap_b32 v96, v24
    v_permlane32_swap_b32 v97, v25
    v_permlane32_swap_b32 v98, v26
    v_permlane32_swap_b32 v99, v27
    s_nop 1
    v_mov_b32 v8, v96 quad_perm:[0,0,2,2] row_mask:0xf bank_mask:0xf
    v_mov_b32 v9, v97 quad_perm:[0,0,2,2] row_mask:0xf bank_mask:0xf
    v_mov_b32 v10, v98 quad_perm:[0,0,2,2] row_mask:0xf bank_mask:0xf
    v_mov_b32 v11, v99 quad_perm:[0,0,2,2] row_mask:0xf bank_mask:0xf
    v_add_f32 v96, v24, v8 quad_perm:[1,1,3,3] row_mask:0xf bank_mask:0xf
    v_add_f32 v97, v25, v9 quad_perm:[1,1,3,3] row_mask:0xf bank_mask:0xf
    v_add_f32 v98, v26, v10 quad_perm:[1,1,3,3] row_mask:0xf bank_mask:0xf
    v_add_f32 v99, v27, v11 quad_perm:[1,1,3,3] row_mask:0xf bank_mask:0xf
    s_waitcnt vmcnt(27)
    v_mfma_f32_16x16x32_bf16 v[104:107], v[116:119], v[16:19], 0
    v_mfma_f32_16x16x32_bf16 v[24:27], v[124:127], v[16:19], 0
    v_mfma_f32_16x16x32_bf16 v[104:107], v[120:123], v[20:23], v[104:107]
    v_mfma_f32_16x16x32_bf16 v[24:27], v[128:131], v[20:23], v[24:27]
    buffer_load_dwordx4 v[116:119], v3, s[12:15], s49 offen offset:768 nt
    s_mov_b32 s49, 28672
    buffer_load_dwordx4 v[120:123], v3, s[12:15], s49 offen offset:0 nt
    buffer_load_dwordx4 v[124:127], v3, s[12:15], s49 offen offset:256 nt
    buffer_load_dwordx4 v[128:131], v3, s[12:15], s49 offen offset:512 nt
    s_nop 3
    v_permlane32_swap_b32 v100, v28
    v_permlane32_swap_b32 v101, v29
    v_permlane32_swap_b32 v102, v30
    v_permlane32_swap_b32 v103, v31
    s_nop 1
    v_mov_b32 v8, v100 quad_perm:[0,0,2,2] row_mask:0xf bank_mask:0xf
    v_mov_b32 v9, v101 quad_perm:[0,0,2,2] row_mask:0xf bank_mask:0xf
    v_mov_b32 v10, v102 quad_perm:[0,0,2,2] row_mask:0xf bank_mask:0xf
    v_mov_b32 v11, v103 quad_perm:[0,0,2,2] row_mask:0xf bank_mask:0xf
    v_add_f32 v100, v28, v8 quad_perm:[1,1,3,3] row_mask:0xf bank_mask:0xf
    v_add_f32 v101, v29, v9 quad_perm:[1,1,3,3] row_mask:0xf bank_mask:0xf
    v_add_f32 v102, v30, v10 quad_perm:[1,1,3,3] row_mask:0xf bank_mask:0xf
    v_add_f32 v103, v31, v11 quad_perm:[1,1,3,3] row_mask:0xf bank_mask:0xf
    s_nop 7
    s_nop 3
    v_permlane32_swap_b32 v104, v24
    v_permlane32_swap_b32 v105, v25
    v_permlane32_swap_b32 v106, v26
    v_permlane32_swap_b32 v107, v27
    s_nop 1
    v_mov_b32 v8, v104 quad_perm:[0,0,2,2] row_mask:0xf bank_mask:0xf
    v_mov_b32 v9, v105 quad_perm:[0,0,2,2] row_mask:0xf bank_mask:0xf
    v_mov_b32 v10, v106 quad_perm:[0,0,2,2] row_mask:0xf bank_mask:0xf
    v_mov_b32 v11, v107 quad_perm:[0,0,2,2] row_mask:0xf bank_mask:0xf
    v_add_f32 v104, v24, v8 quad_perm:[1,1,3,3] row_mask:0xf bank_mask:0xf
    v_add_f32 v105, v25, v9 quad_perm:[1,1,3,3] row_mask:0xf bank_mask:0xf
    v_add_f32 v106, v26, v10 quad_perm:[1,1,3,3] row_mask:0xf bank_mask:0xf
    v_add_f32 v107, v27, v11 quad_perm:[1,1,3,3] row_mask:0xf bank_mask:0xf
    s_lshl_b32 s50, s4, 19
    s_lshl_b32 s53, s6, 15
    s_add_u32 s50, s50, s53
    v_lshlrev_b32 v6, 1, v0
    s_add_u32 s53, s50, 0
    buffer_load_ushort v232, v6, s[20:23], s53 offen offset:0
    buffer_load_ushort v16, v6, s[20:23], s53 offen offset:1024
    buffer_load_ushort v233, v6, s[20:23], s53 offen offset:2048
    buffer_load_ushort v17, v6, s[20:23], s53 offen offset:3072
    s_add_u32 s53, s50, 4096
    buffer_load_ushort v234, v6, s[20:23], s53 offen offset:0
    buffer_load_ushort v18, v6, s[20:23], s53 offen offset:1024
    buffer_load_ushort v235, v6, s[20:23], s53 offen offset:2048
    buffer_load_ushort v19, v6, s[20:23], s53 offen offset:3072
    s_add_u32 s53, s50, 8192
    buffer_load_ushort v236, v6, s[20:23], s53 offen offset:0
    buffer_load_ushort v20, v6, s[20:23], s53 offen offset:1024
    buffer_load_ushort v237, v6, s[20:23], s53 offen offset:2048
    buffer_load_ushort v21, v6, s[20:23], s53 offen offset:3072
    s_add_u32 s53, s50, 12288
    buffer_load_ushort v238, v6, s[20:23], s53 offen offset:0
    buffer_load_ushort v22, v6, s[20:23], s53 offen offset:1024
    buffer_load_ushort v239, v6, s[20:23], s53 offen offset:2048
    buffer_load_ushort v23, v6, s[20:23], s53 offen offset:3072
    s_add_u32 s53, s50, 16384
    buffer_load_ushort v240, v6, s[20:23], s53 offen offset:0
    buffer_load_ushort v24, v6, s[20:23], s53 offen offset:1024
    buffer_load_ushort v241, v6, s[20:23], s53 offen offset:2048
    buffer_load_ushort v25, v6, s[20:23], s53 offen offset:3072
    s_add_u32 s53, s50, 20480
    buffer_load_ushort v242, v6, s[20:23], s53 offen offset:0
    buffer_load_ushort v26, v6, s[20:23], s53 offen offset:1024
    buffer_load_ushort v243, v6, s[20:23], s53 offen offset:2048
    buffer_load_ushort v27, v6, s[20:23], s53 offen offset:3072
    s_add_u32 s53, s50, 24576
    buffer_load_ushort v244, v6, s[20:23], s53 offen offset:0
    buffer_load_ushort v28, v6, s[20:23], s53 offen offset:1024
    buffer_load_ushort v245, v6, s[20:23], s53 offen offset:2048
    buffer_load_ushort v29, v6, s[20:23], s53 offen offset:3072
    s_add_u32 s53, s50, 28672
    buffer_load_ushort v246, v6, s[20:23], s53 offen offset:0
    buffer_load_ushort v30, v6, s[20:23], s53 offen offset:1024
    buffer_load_ushort v247, v6, s[20:23], s53 offen offset:2048
    buffer_load_ushort v31, v6, s[20:23], s53 offen offset:3072
    v_mov_b32 v7, 0
    s_lshl_b32 s50, s5, 10
    s_lshl_b32 s53, s51, 3
    s_add_u32 s50, s50, s53
    buffer_load_dwordx2 v[250:251], v7, s[24:27], s50 offen
    s_nop 7
    v_max3_f32 v8, v40, v41, v42
    v_max3_f32 v9, v43, v44, v45
    v_max3_f32 v8, v8, v46, v47
    v_max3_f32 v9, v9, v48, v49
    v_max3_f32 v8, v8, v50, v51
    v_max3_f32 v9, v9, v52, v53
    v_max3_f32 v8, v8, v54, v55
    v_max3_f32 v9, v9, v56, v57
    v_max3_f32 v8, v8, v58, v59
    v_max3_f32 v9, v9, v60, v61
    v_max3_f32 v8, v8, v62, v63
    v_max3_f32 v9, v9, v64, v65
    v_max3_f32 v8, v8, v66, v67
    v_max3_f32 v9, v9, v68, v69
    v_max3_f32 v8, v8, v70, v71
    v_max3_f32 v9, v9, v72, v73
    v_max3_f32 v8, v8, v74, v75
    v_max3_f32 v9, v9, v76, v77
    v_max3_f32 v8, v8, v78, v79
    v_max3_f32 v9, v9, v80, v81
    v_max3_f32 v8, v8, v82, v83
    v_max3_f32 v9, v9, v84, v85
    v_max3_f32 v8, v8, v86, v87
    v_max3_f32 v9, v9, v88, v89
    v_max3_f32 v8, v8, v90, v91
    v_max3_f32 v9, v9, v92, v93
    v_max3_f32 v8, v8, v94, v95
    v_max3_f32 v9, v9, v96, v97
    v_max3_f32 v8, v8, v98, v99
    v_max3_f32 v9, v9, v100, v101
    v_max3_f32 v8, v8, v102, v103
    v_max3_f32 v9, v9, v104, v105
    v_max3_f32 v8, v8, v106, v107
    v_max_f32 v8, v8, v9
    v_mov_b32 v9, v8
    s_nop 1
    v_permlane16_swap_b32 v8, v9
    s_nop 1
    v_max_f32 v8, v8, v9
    v_mov_b32 v9, v8
    s_nop 1
    v_permlane32_swap_b32 v8, v9
    s_nop 1
    v_max_f32 v8, v8, v9
    v_mov_b32 v249, v8
    v_mul_f32 v10, s52, v8
    v_sub_f32 v10, 0, v10
    v_fma_f32 v40, v40, s52, v10
    v_fma_f32 v41, v41, s52, v10
    v_fma_f32 v42, v42, s52, v10
    v_fma_f32 v43, v43, s52, v10
    v_fma_f32 v44, v44, s52, v10
    v_fma_f32 v45, v45, s52, v10
    v_fma_f32 v46, v46, s52, v10
    v_fma_f32 v47, v47, s52, v10
    v_fma_f32 v48, v48, s52, v10
    v_fma_f32 v49, v49, s52, v10
    v_fma_f32 v50, v50, s52, v10
    v_fma_f32 v51, v51, s52, v10
    v_fma_f32 v52, v52, s52, v10
    v_fma_f32 v53, v53, s52, v10
    v_fma_f32 v54, v54, s52, v10
    v_fma_f32 v55, v55, s52, v10
    v_fma_f32 v56, v56, s52, v10
    v_fma_f32 v57, v57, s52, v10
    v_fma_f32 v58, v58, s52, v10
    v_fma_f32 v59, v59, s52, v10
    v_fma_f32 v60, v60, s52, v10
    v_fma_f32 v61, v61, s52, v10
    v_fma_f32 v62, v62, s52, v10
    v_fma_f32 v63, v63, s52, v10
    v_fma_f32 v64, v64, s52, v10
    v_fma_f32 v65, v65, s52, v10
    v_fma_f32 v66, v66, s52, v10
    v_fma_f32 v67, v67, s52, v10
    v_fma_f32 v68, v68, s52, v10
    v_fma_f32 v69, v69, s52, v10
    v_fma_f32 v70, v70, s52, v10
    v_fma_f32 v71, v71, s52, v10
    v_fma_f32 v72, v72, s52, v10
    v_fma_f32 v73, v73, s52, v10
    v_fma_f32 v74, v74, s52, v10
    v_fma_f32 v75, v75, s52, v10
    v_fma_f32 v76, v76, s52, v10
    v_fma_f32 v77, v77, s52, v10
    v_fma_f32 v78, v78, s52, v10
    v_fma_f32 v79, v79, s52, v10
    v_fma_f32 v80, v80, s52, v10
    v_fma_f32 v81, v81, s52, v10
    v_fma_f32 v82, v82, s52, v10
    v_fma_f32 v83, v83, s52, v10
    v_fma_f32 v84, v84, s52, v10
    v_fma_f32 v85, v85, s52, v10
    v_fma_f32 v86, v86, s52, v10
    v_fma_f32 v87, v87, s52, v10
    v_fma_f32 v88, v88, s52, v10
    v_fma_f32 v89, v89, s52, v10
    v_fma_f32 v90, v90, s52, v10
    v_fma_f32 v91, v91, s52, v10
    v_fma_f32 v92, v92, s52, v10
    v_fma_f32 v93, v93, s52, v10
    v_fma_f32 v94, v94, s52, v10
    v_fma_f32 v95, v95, s52, v10
    v_fma_f32 v96, v96, s52, v10
    v_fma_f32 v97, v97, s52, v10
    v_fma_f32 v98, v98, s52, v10
    v_fma_f32 v99, v99, s52, v10
    v_fma_f32 v100, v100, s52, v10
    v_fma_f32 v101, v101, s52, v10
    v_fma_f32 v102, v102, s52, v10
    v_fma_f32 v103, v103, s52, v10
    v_fma_f32 v104, v104, s52, v10
    v_fma_f32 v105, v105, s52, v10
    v_fma_f32 v106, v106, s52, v10
    v_fma_f32 v107, v107, s52, v10
    v_exp_f32 v40, v40
    v_exp_f32 v41, v41
    v_exp_f32 v42, v42
    v_exp_f32 v43, v43
    v_exp_f32 v44, v44
    v_exp_f32 v45, v45
    v_exp_f32 v46, v46
    v_exp_f32 v47, v47
    v_exp_f32 v48, v48
    v_exp_f32 v49, v49
    v_exp_f32 v50, v50
    v_exp_f32 v51, v51
    v_exp_f32 v52, v52
    v_exp_f32 v53, v53
    v_exp_f32 v54, v54
    v_exp_f32 v55, v55
    v_exp_f32 v56, v56
    v_exp_f32 v57, v57
    v_exp_f32 v58, v58
    v_exp_f32 v59, v59
    v_exp_f32 v60, v60
    v_exp_f32 v61, v61
    v_exp_f32 v62, v62
    v_exp_f32 v63, v63
    v_exp_f32 v64, v64
    v_exp_f32 v65, v65
    v_exp_f32 v66, v66
    v_exp_f32 v67, v67
    v_exp_f32 v68, v68
    v_exp_f32 v69, v69
    v_exp_f32 v70, v70
    v_exp_f32 v71, v71
    v_exp_f32 v72, v72
    v_exp_f32 v73, v73
    v_exp_f32 v74, v74
    v_exp_f32 v75, v75
    v_exp_f32 v76, v76
    v_exp_f32 v77, v77
    v_exp_f32 v78, v78
    v_exp_f32 v79, v79
    v_exp_f32 v80, v80
    v_exp_f32 v81, v81
    v_exp_f32 v82, v82
    v_exp_f32 v83, v83
    v_exp_f32 v84, v84
    v_exp_f32 v85, v85
    v_exp_f32 v86, v86
    v_exp_f32 v87, v87
    v_exp_f32 v88, v88
    v_exp_f32 v89, v89
    v_exp_f32 v90, v90
    v_exp_f32 v91, v91
    v_exp_f32 v92, v92
    v_exp_f32 v93, v93
    v_exp_f32 v94, v94
    v_exp_f32 v95, v95
    v_exp_f32 v96, v96
    v_exp_f32 v97, v97
    v_exp_f32 v98, v98
    v_exp_f32 v99, v99
    v_exp_f32 v100, v100
    v_exp_f32 v101, v101
    v_exp_f32 v102, v102
    v_exp_f32 v103, v103
    v_exp_f32 v104, v104
    v_exp_f32 v105, v105
    v_exp_f32 v106, v106
    v_exp_f32 v107, v107
    s_nop 0
    v_add_f32 v12, v40, v44
    v_add_f32 v13, v41, v45
    v_add_f32 v14, v42, v46
    v_add_f32 v15, v43, v47
    v_add_f32 v12, v12, v48
    v_add_f32 v13, v13, v49
    v_add_f32 v14, v14, v50
    v_add_f32 v15, v15, v51
    v_add_f32 v12, v12, v52
    v_add_f32 v13, v13, v53
    v_add_f32 v14, v14, v54
    v_add_f32 v15, v15, v55
    v_add_f32 v12, v12, v56
    v_add_f32 v13, v13, v57
    v_add_f32 v14, v14, v58
    v_add_f32 v15, v15, v59
    v_add_f32 v12, v12, v60
    v_add_f32 v13, v13, v61
    v_add_f32 v14, v14, v62
    v_add_f32 v15, v15, v63
    v_add_f32 v12, v12, v64
    v_add_f32 v13, v13, v65
    v_add_f32 v14, v14, v66
    v_add_f32 v15, v15, v67
    v_add_f32 v12, v12, v68
    v_add_f32 v13, v13, v69
    v_add_f32 v14, v14, v70
    v_add_f32 v15, v15, v71
    v_add_f32 v12, v12, v72
    v_add_f32 v13, v13, v73
    v_add_f32 v14, v14, v74
    v_add_f32 v15, v15, v75
    v_add_f32 v12, v12, v76
    v_add_f32 v13, v13, v77
    v_add_f32 v14, v14, v78
    v_add_f32 v15, v15, v79
    v_add_f32 v12, v12, v80
    v_add_f32 v13, v13, v81
    v_add_f32 v14, v14, v82
    v_add_f32 v15, v15, v83
    v_add_f32 v12, v12, v84
    v_add_f32 v13, v13, v85
    v_add_f32 v14, v14, v86
    v_add_f32 v15, v15, v87
    v_add_f32 v12, v12, v88
    v_add_f32 v13, v13, v89
    v_add_f32 v14, v14, v90
    v_add_f32 v15, v15, v91
    v_add_f32 v12, v12, v92
    v_add_f32 v13, v13, v93
    v_add_f32 v14, v14, v94
    v_add_f32 v15, v15, v95
    v_add_f32 v12, v12, v96
    v_add_f32 v13, v13, v97
    v_add_f32 v14, v14, v98
    v_add_f32 v15, v15, v99
    v_add_f32 v12, v12, v100
    v_add_f32 v13, v13, v101
    v_add_f32 v14, v14, v102
    v_add_f32 v15, v15, v103
    v_add_f32 v12, v12, v104
    v_add_f32 v13, v13, v105
    v_add_f32 v14, v14, v106
    v_add_f32 v15, v15, v107
    v_add_f32 v12, v12, v13
    v_add_f32 v14, v14, v15
    v_add_f32 v12, v12, v14
    v_mov_b32 v13, v12
    s_nop 1
    v_permlane16_swap_b32 v12, v13
    s_nop 1
    v_add_f32 v12, v12, v13
    v_mov_b32 v13, v12
    s_nop 1
    v_permlane32_swap_b32 v12, v13
    s_nop 1
    v_add_f32 v12, v12, v13
    v_mov_b32 v252, v12
    v_cvt_pk_bf16_f32 v9, v40, v40
    v_and_b32 v8, v9, v4
    v_and_b32 v9, v9, v5
    v_cvt_pk_bf16_f32 v11, v41, v41
    v_and_b32 v10, v11, v4
    v_and_b32 v11, v11, v5
    s_waitcnt vmcnt(63)
    v_mfma_f32_16x16x16_bf16 v[32:35], v[8:9], v[132:133], 0
    v_mfma_f32_16x16x16_bf16 v[36:39], v[8:9], v[134:135], 0
    buffer_load_dwordx4 v[132:135], v3, s[12:15], s49 offen offset:768 nt
    v_cvt_pk_bf16_f32 v13, v42, v42
    v_and_b32 v12, v13, v4
    v_and_b32 v13, v13, v5
    s_waitcnt vmcnt(63)
    v_mfma_f32_16x16x16_bf16 v[32:35], v[10:11], v[136:137], v[32:35]
    v_mfma_f32_16x16x16_bf16 v[36:39], v[10:11], v[138:139], v[36:39]
    s_mov_b32 s49, 32768
    buffer_load_dwordx4 v[136:139], v3, s[12:15], s49 offen offset:0 nt
    v_cvt_pk_bf16_f32 v15, v43, v43
    v_and_b32 v14, v15, v4
    v_and_b32 v15, v15, v5
    s_waitcnt vmcnt(63)
    v_mfma_f32_16x16x16_bf16 v[32:35], v[12:13], v[140:141], v[32:35]
    v_mfma_f32_16x16x16_bf16 v[36:39], v[12:13], v[142:143], v[36:39]
    buffer_load_dwordx4 v[140:143], v3, s[12:15], s49 offen offset:256 nt
    v_cvt_pk_bf16_f32 v9, v44, v44
    v_and_b32 v8, v9, v4
    v_and_b32 v9, v9, v5
    s_waitcnt vmcnt(63)
    v_mfma_f32_16x16x16_bf16 v[32:35], v[14:15], v[144:145], v[32:35]
    v_mfma_f32_16x16x16_bf16 v[36:39], v[14:15], v[146:147], v[36:39]
    buffer_load_dwordx4 v[144:147], v3, s[12:15], s49 offen offset:512 nt
    v_cvt_pk_bf16_f32 v11, v45, v45
    v_and_b32 v10, v11, v4
    v_and_b32 v11, v11, v5
    s_waitcnt vmcnt(63)
    v_mfma_f32_16x16x16_bf16 v[32:35], v[8:9], v[148:149], v[32:35]
    v_mfma_f32_16x16x16_bf16 v[36:39], v[8:9], v[150:151], v[36:39]
    buffer_load_dwordx4 v[148:151], v3, s[12:15], s49 offen offset:768 nt
    v_cvt_pk_bf16_f32 v13, v46, v46
    v_and_b32 v12, v13, v4
    v_and_b32 v13, v13, v5
    s_waitcnt vmcnt(63)
    v_mfma_f32_16x16x16_bf16 v[32:35], v[10:11], v[152:153], v[32:35]
    v_mfma_f32_16x16x16_bf16 v[36:39], v[10:11], v[154:155], v[36:39]
    s_mov_b32 s49, 36864
    buffer_load_dwordx4 v[152:155], v3, s[12:15], s49 offen offset:0 nt
    v_cvt_pk_bf16_f32 v15, v47, v47
    v_and_b32 v14, v15, v4
    v_and_b32 v15, v15, v5
    s_waitcnt vmcnt(63)
    v_mfma_f32_16x16x16_bf16 v[32:35], v[12:13], v[156:157], v[32:35]
    v_mfma_f32_16x16x16_bf16 v[36:39], v[12:13], v[158:159], v[36:39]
    buffer_load_dwordx4 v[156:159], v3, s[12:15], s49 offen offset:256 nt
    v_cvt_pk_bf16_f32 v9, v48, v48
    v_and_b32 v8, v9, v4
    v_and_b32 v9, v9, v5
    s_waitcnt vmcnt(63)
    v_mfma_f32_16x16x16_bf16 v[32:35], v[14:15], v[160:161], v[32:35]
    v_mfma_f32_16x16x16_bf16 v[36:39], v[14:15], v[162:163], v[36:39]
    buffer_load_dwordx4 v[160:163], v3, s[12:15], s49 offen offset:512 nt
    v_cvt_pk_bf16_f32 v11, v49, v49
    v_and_b32 v10, v11, v4
    v_and_b32 v11, v11, v5
    s_waitcnt vmcnt(63)
    v_mfma_f32_16x16x16_bf16 v[32:35], v[8:9], v[164:165], v[32:35]
    v_mfma_f32_16x16x16_bf16 v[36:39], v[8:9], v[166:167], v[36:39]
    buffer_load_dwordx4 v[164:167], v3, s[12:15], s49 offen offset:768 nt
    v_cvt_pk_bf16_f32 v13, v50, v50
    v_and_b32 v12, v13, v4
    v_and_b32 v13, v13, v5
    s_waitcnt vmcnt(63)
    v_mfma_f32_16x16x16_bf16 v[32:35], v[10:11], v[168:169], v[32:35]
    v_mfma_f32_16x16x16_bf16 v[36:39], v[10:11], v[170:171], v[36:39]
    s_mov_b32 s49, 40960
    buffer_load_dwordx4 v[168:171], v3, s[12:15], s49 offen offset:0 nt
    v_cvt_pk_bf16_f32 v15, v51, v51
    v_and_b32 v14, v15, v4
    v_and_b32 v15, v15, v5
    s_waitcnt vmcnt(63)
    v_mfma_f32_16x16x16_bf16 v[32:35], v[12:13], v[172:173], v[32:35]
    v_mfma_f32_16x16x16_bf16 v[36:39], v[12:13], v[174:175], v[36:39]
    buffer_load_dwordx4 v[172:175], v3, s[12:15], s49 offen offset:256 nt
    v_cvt_pk_bf16_f32 v9, v52, v52
    v_and_b32 v8, v9, v4
    v_and_b32 v9, v9, v5
    s_waitcnt vmcnt(63)
    v_mfma_f32_16x16x16_bf16 v[32:35], v[14:15], v[176:177], v[32:35]
    v_mfma_f32_16x16x16_bf16 v[36:39], v[14:15], v[178:179], v[36:39]
    buffer_load_dwordx4 v[176:179], v3, s[12:15], s49 offen offset:512 nt
    v_cvt_pk_bf16_f32 v11, v53, v53
    v_and_b32 v10, v11, v4
    v_and_b32 v11, v11, v5
    s_waitcnt vmcnt(63)
    v_mfma_f32_16x16x16_bf16 v[32:35], v[8:9], v[180:181], v[32:35]
    v_mfma_f32_16x16x16_bf16 v[36:39], v[8:9], v[182:183], v[36:39]
    buffer_load_dwordx4 v[180:183], v3, s[12:15], s49 offen offset:768 nt
    v_cvt_pk_bf16_f32 v13, v54, v54
    v_and_b32 v12, v13, v4
    v_and_b32 v13, v13, v5
    s_waitcnt vmcnt(63)
    v_mfma_f32_16x16x16_bf16 v[32:35], v[10:11], v[184:185], v[32:35]
    v_mfma_f32_16x16x16_bf16 v[36:39], v[10:11], v[186:187], v[36:39]
    s_mov_b32 s49, 45056
    buffer_load_dwordx4 v[184:187], v3, s[12:15], s49 offen offset:0 nt
    v_cvt_pk_bf16_f32 v15, v55, v55
    v_and_b32 v14, v15, v4
    v_and_b32 v15, v15, v5
    s_waitcnt vmcnt(63)
    v_mfma_f32_16x16x16_bf16 v[32:35], v[12:13], v[188:189], v[32:35]
    v_mfma_f32_16x16x16_bf16 v[36:39], v[12:13], v[190:191], v[36:39]
    buffer_load_dwordx4 v[188:191], v3, s[12:15], s49 offen offset:256 nt
    v_cvt_pk_bf16_f32 v9, v56, v56
    v_and_b32 v8, v9, v4
    v_and_b32 v9, v9, v5
    s_waitcnt vmcnt(63)
    v_mfma_f32_16x16x16_bf16 v[32:35], v[14:15], v[192:193], v[32:35]
    v_mfma_f32_16x16x16_bf16 v[36:39], v[14:15], v[194:195], v[36:39]
    buffer_load_dwordx4 v[192:195], v3, s[12:15], s49 offen offset:512 nt
    v_cvt_pk_bf16_f32 v11, v57, v57
    v_and_b32 v10, v11, v4
    v_and_b32 v11, v11, v5
    s_waitcnt vmcnt(63)
    v_mfma_f32_16x16x16_bf16 v[32:35], v[8:9], v[196:197], v[32:35]
    v_mfma_f32_16x16x16_bf16 v[36:39], v[8:9], v[198:199], v[36:39]
    buffer_load_dwordx4 v[196:199], v3, s[12:15], s49 offen offset:768 nt
    v_cvt_pk_bf16_f32 v13, v58, v58
    v_and_b32 v12, v13, v4
    v_and_b32 v13, v13, v5
    s_waitcnt vmcnt(63)
    v_mfma_f32_16x16x16_bf16 v[32:35], v[10:11], v[200:201], v[32:35]
    v_mfma_f32_16x16x16_bf16 v[36:39], v[10:11], v[202:203], v[36:39]
    s_mov_b32 s49, 49152
    buffer_load_dwordx4 v[200:203], v3, s[12:15], s49 offen offset:0 nt
    v_cvt_pk_bf16_f32 v15, v59, v59
    v_and_b32 v14, v15, v4
    v_and_b32 v15, v15, v5
    s_waitcnt vmcnt(63)
    v_mfma_f32_16x16x16_bf16 v[32:35], v[12:13], v[204:205], v[32:35]
    v_mfma_f32_16x16x16_bf16 v[36:39], v[12:13], v[206:207], v[36:39]
    buffer_load_dwordx4 v[204:207], v3, s[12:15], s49 offen offset:256 nt
    v_cvt_pk_bf16_f32 v9, v60, v60
    v_and_b32 v8, v9, v4
    v_and_b32 v9, v9, v5
    s_waitcnt vmcnt(63)
    v_mfma_f32_16x16x16_bf16 v[32:35], v[14:15], v[208:209], v[32:35]
    v_mfma_f32_16x16x16_bf16 v[36:39], v[14:15], v[210:211], v[36:39]
    buffer_load_dwordx4 v[208:211], v3, s[12:15], s49 offen offset:512 nt
    v_cvt_pk_bf16_f32 v11, v61, v61
    v_and_b32 v10, v11, v4
    v_and_b32 v11, v11, v5
    s_waitcnt vmcnt(63)
    v_mfma_f32_16x16x16_bf16 v[32:35], v[8:9], v[212:213], v[32:35]
    v_mfma_f32_16x16x16_bf16 v[36:39], v[8:9], v[214:215], v[36:39]
    buffer_load_dwordx4 v[212:215], v3, s[12:15], s49 offen offset:768 nt
    v_cvt_pk_bf16_f32 v13, v62, v62
    v_and_b32 v12, v13, v4
    v_and_b32 v13, v13, v5
    s_waitcnt vmcnt(63)
    v_mfma_f32_16x16x16_bf16 v[32:35], v[10:11], v[216:217], v[32:35]
    v_mfma_f32_16x16x16_bf16 v[36:39], v[10:11], v[218:219], v[36:39]
    s_mov_b32 s49, 53248
    buffer_load_dwordx4 v[216:219], v3, s[12:15], s49 offen offset:0 nt
    v_cvt_pk_bf16_f32 v15, v63, v63
    v_and_b32 v14, v15, v4
    v_and_b32 v15, v15, v5
    s_waitcnt vmcnt(63)
    v_mfma_f32_16x16x16_bf16 v[32:35], v[12:13], v[220:221], v[32:35]
    v_mfma_f32_16x16x16_bf16 v[36:39], v[12:13], v[222:223], v[36:39]
    buffer_load_dwordx4 v[220:223], v3, s[12:15], s49 offen offset:256 nt
    v_cvt_pk_bf16_f32 v9, v64, v64
    v_and_b32 v8, v9, v4
    v_and_b32 v9, v9, v5
    s_waitcnt vmcnt(63)
    v_mfma_f32_16x16x16_bf16 v[32:35], v[14:15], v[224:225], v[32:35]
    v_mfma_f32_16x16x16_bf16 v[36:39], v[14:15], v[226:227], v[36:39]
    buffer_load_dwordx4 v[224:227], v3, s[12:15], s49 offen offset:512 nt
    v_cvt_pk_bf16_f32 v11, v65, v65
    v_and_b32 v10, v11, v4
    v_and_b32 v11, v11, v5
    s_waitcnt vmcnt(63)
    v_mfma_f32_16x16x16_bf16 v[32:35], v[8:9], v[228:229], v[32:35]
    v_mfma_f32_16x16x16_bf16 v[36:39], v[8:9], v[230:231], v[36:39]
    buffer_load_dwordx4 v[228:231], v3, s[12:15], s49 offen offset:768 nt
    v_cvt_pk_bf16_f32 v13, v66, v66
    v_and_b32 v12, v13, v4
    v_and_b32 v13, v13, v5
    s_waitcnt vmcnt(63)
    v_mfma_f32_16x16x16_bf16 v[32:35], v[10:11], v[108:109], v[32:35]
    v_mfma_f32_16x16x16_bf16 v[36:39], v[10:11], v[110:111], v[36:39]
    s_mov_b32 s49, 57344
    buffer_load_dwordx4 v[108:111], v3, s[12:15], s49 offen offset:0 nt
    v_cvt_pk_bf16_f32 v15, v67, v67
    v_and_b32 v14, v15, v4
    v_and_b32 v15, v15, v5
    s_waitcnt vmcnt(63)
    v_mfma_f32_16x16x16_bf16 v[32:35], v[12:13], v[112:113], v[32:35]
    v_mfma_f32_16x16x16_bf16 v[36:39], v[12:13], v[114:115], v[36:39]
    buffer_load_dwordx4 v[112:115], v3, s[12:15], s49 offen offset:256 nt
    v_cvt_pk_bf16_f32 v9, v68, v68
    v_and_b32 v8, v9, v4
    v_and_b32 v9, v9, v5
    s_waitcnt vmcnt(63)
    v_mfma_f32_16x16x16_bf16 v[32:35], v[14:15], v[116:117], v[32:35]
    v_mfma_f32_16x16x16_bf16 v[36:39], v[14:15], v[118:119], v[36:39]
    buffer_load_dwordx4 v[116:119], v3, s[12:15], s49 offen offset:512 nt
    v_cvt_pk_bf16_f32 v11, v69, v69
    v_and_b32 v10, v11, v4
    v_and_b32 v11, v11, v5
    s_waitcnt vmcnt(63)
    v_mfma_f32_16x16x16_bf16 v[32:35], v[8:9], v[120:121], v[32:35]
    v_mfma_f32_16x16x16_bf16 v[36:39], v[8:9], v[122:123], v[36:39]
    buffer_load_dwordx4 v[120:123], v3, s[12:15], s49 offen offset:768 nt
    v_cvt_pk_bf16_f32 v13, v70, v70
    v_and_b32 v12, v13, v4
    v_and_b32 v13, v13, v5
    s_waitcnt vmcnt(63)
    v_mfma_f32_16x16x16_bf16 v[32:35], v[10:11], v[124:125], v[32:35]
    v_mfma_f32_16x16x16_bf16 v[36:39], v[10:11], v[126:127], v[36:39]
    s_mov_b32 s49, 61440
    buffer_load_dwordx4 v[124:127], v3, s[12:15], s49 offen offset:0 nt
    v_cvt_pk_bf16_f32 v15, v71, v71
    v_and_b32 v14, v15, v4
    v_and_b32 v15, v15, v5
    s_waitcnt vmcnt(63)
    v_mfma_f32_16x16x16_bf16 v[32:35], v[12:13], v[128:129], v[32:35]
    v_mfma_f32_16x16x16_bf16 v[36:39], v[12:13], v[130:131], v[36:39]
    buffer_load_dwordx4 v[128:131], v3, s[12:15], s49 offen offset:256 nt
    v_cvt_pk_bf16_f32 v9, v72, v72
    v_and_b32 v8, v9, v4
    v_and_b32 v9, v9, v5
    s_waitcnt vmcnt(30)
    v_mfma_f32_16x16x16_bf16 v[32:35], v[14:15], v[132:133], v[32:35]
    v_mfma_f32_16x16x16_bf16 v[36:39], v[14:15], v[134:135], v[36:39]
    buffer_load_dwordx4 v[132:135], v3, s[12:15], s49 offen offset:512 nt
    v_cvt_pk_bf16_f32 v11, v73, v73
    v_and_b32 v10, v11, v4
    v_and_b32 v11, v11, v5
    s_waitcnt vmcnt(30)
    v_mfma_f32_16x16x16_bf16 v[32:35], v[8:9], v[136:137], v[32:35]
    v_mfma_f32_16x16x16_bf16 v[36:39], v[8:9], v[138:139], v[36:39]
    buffer_load_dwordx4 v[136:139], v3, s[12:15], s49 offen offset:768 nt
    v_cvt_pk_bf16_f32 v13, v74, v74
    v_and_b32 v12, v13, v4
    v_and_b32 v13, v13, v5
    s_waitcnt vmcnt(30)
    v_mfma_f32_16x16x16_bf16 v[32:35], v[10:11], v[140:141], v[32:35]
    v_mfma_f32_16x16x16_bf16 v[36:39], v[10:11], v[142:143], v[36:39]
    s_mov_b32 s49, 65536
    buffer_load_dwordx4 v[140:143], v3, s[12:15], s49 offen offset:0 nt
    v_lshl_or_b32 v232, v16, 16, v232
    v_lshl_or_b32 v233, v17, 16, v233
    v_lshl_or_b32 v234, v18, 16, v234
    v_lshl_or_b32 v235, v19, 16, v235
    v_lshl_or_b32 v236, v20, 16, v236
    v_lshl_or_b32 v237, v21, 16, v237
    v_lshl_or_b32 v238, v22, 16, v238
    v_lshl_or_b32 v239, v23, 16, v239
    v_lshl_or_b32 v240, v24, 16, v240
    v_lshl_or_b32 v241, v25, 16, v241
    v_lshl_or_b32 v242, v26, 16, v242
    v_lshl_or_b32 v243, v27, 16, v243
    v_lshl_or_b32 v244, v28, 16, v244
    v_lshl_or_b32 v245, v29, 16, v245
    v_lshl_or_b32 v246, v30, 16, v246
    v_lshl_or_b32 v247, v31, 16, v247
    v_cvt_pk_bf16_f32 v15, v75, v75
    v_and_b32 v14, v15, v4
    v_and_b32 v15, v15, v5
    s_waitcnt vmcnt(30)
    v_mfma_f32_16x16x16_bf16 v[32:35], v[12:13], v[144:145], v[32:35]
    v_mfma_f32_16x16x16_bf16 v[36:39], v[12:13], v[146:147], v[36:39]
    buffer_load_dwordx4 v[144:147], v3, s[12:15], s49 offen offset:256 nt
    v_cvt_pk_bf16_f32 v9, v76, v76
    v_and_b32 v8, v9, v4
    v_and_b32 v9, v9, v5
    s_waitcnt vmcnt(30)
    v_mfma_f32_16x16x16_bf16 v[32:35], v[14:15], v[148:149], v[32:35]
    v_mfma_f32_16x16x16_bf16 v[36:39], v[14:15], v[150:151], v[36:39]
    buffer_load_dwordx4 v[148:151], v3, s[12:15], s49 offen offset:512 nt
    v_cvt_pk_bf16_f32 v11, v77, v77
    v_and_b32 v10, v11, v4
    v_and_b32 v11, v11, v5
    s_waitcnt vmcnt(30)
    v_mfma_f32_16x16x16_bf16 v[32:35], v[8:9], v[152:153], v[32:35]
    v_mfma_f32_16x16x16_bf16 v[36:39], v[8:9], v[154:155], v[36:39]
    buffer_load_dwordx4 v[152:155], v3, s[12:15], s49 offen offset:768 nt
    v_cvt_pk_bf16_f32 v13, v78, v78
    v_and_b32 v12, v13, v4
    v_and_b32 v13, v13, v5
    s_waitcnt vmcnt(30)
    v_mfma_f32_16x16x16_bf16 v[32:35], v[10:11], v[156:157], v[32:35]
    v_mfma_f32_16x16x16_bf16 v[36:39], v[10:11], v[158:159], v[36:39]
    v_cvt_pk_bf16_f32 v15, v79, v79
    v_and_b32 v14, v15, v4
    v_and_b32 v15, v15, v5
    s_waitcnt vmcnt(29)
    v_mfma_f32_16x16x16_bf16 v[32:35], v[12:13], v[160:161], v[32:35]
    v_mfma_f32_16x16x16_bf16 v[36:39], v[12:13], v[162:163], v[36:39]
    v_cvt_pk_bf16_f32 v9, v80, v80
    v_and_b32 v8, v9, v4
    v_and_b32 v9, v9, v5
    s_waitcnt vmcnt(28)
    v_mfma_f32_16x16x16_bf16 v[32:35], v[14:15], v[164:165], v[32:35]
    v_mfma_f32_16x16x16_bf16 v[36:39], v[14:15], v[166:167], v[36:39]
    v_cvt_pk_bf16_f32 v11, v81, v81
    v_and_b32 v10, v11, v4
    v_and_b32 v11, v11, v5
    s_waitcnt vmcnt(27)
    v_mfma_f32_16x16x16_bf16 v[32:35], v[8:9], v[168:169], v[32:35]
    v_mfma_f32_16x16x16_bf16 v[36:39], v[8:9], v[170:171], v[36:39]
    s_cmp_lg_u32 s3, 0
    s_cbranch_scc1 L_NOFLC
    buffer_load_dword v253, v248, s[40:43], 0 offen sc0 sc1
L_NOFLC:
    v_cvt_pk_bf16_f32 v13, v82, v82
    v_and_b32 v12, v13, v4
    v_and_b32 v13, v13, v5
    s_waitcnt vmcnt(26)
    v_mfma_f32_16x16x16_bf16 v[32:35], v[10:11], v[172:173], v[32:35]
    v_mfma_f32_16x16x16_bf16 v[36:39], v[10:11], v[174:175], v[36:39]
    v_cvt_pk_bf16_f32 v15, v83, v83
    v_and_b32 v14, v15, v4
    v_and_b32 v15, v15, v5
    s_waitcnt vmcnt(25)
    v_mfma_f32_16x16x16_bf16 v[32:35], v[12:13], v[176:177], v[32:35]
    v_mfma_f32_16x16x16_bf16 v[36:39], v[12:13], v[178:179], v[36:39]
    v_cvt_pk_bf16_f32 v9, v84, v84
    v_and_b32 v8, v9, v4
    v_and_b32 v9, v9, v5
    s_waitcnt vmcnt(24)
    v_mfma_f32_16x16x16_bf16 v[32:35], v[14:15], v[180:181], v[32:35]
    v_mfma_f32_16x16x16_bf16 v[36:39], v[14:15], v[182:183], v[36:39]
    v_cvt_pk_bf16_f32 v11, v85, v85
    v_and_b32 v10, v11, v4
    v_and_b32 v11, v11, v5
    s_waitcnt vmcnt(23)
    v_mfma_f32_16x16x16_bf16 v[32:35], v[8:9], v[184:185], v[32:35]
    v_mfma_f32_16x16x16_bf16 v[36:39], v[8:9], v[186:187], v[36:39]
    v_cvt_pk_bf16_f32 v13, v86, v86
    v_and_b32 v12, v13, v4
    v_and_b32 v13, v13, v5
    s_waitcnt vmcnt(22)
    v_mfma_f32_16x16x16_bf16 v[32:35], v[10:11], v[188:189], v[32:35]
    v_mfma_f32_16x16x16_bf16 v[36:39], v[10:11], v[190:191], v[36:39]
    v_cvt_pk_bf16_f32 v15, v87, v87
    v_and_b32 v14, v15, v4
    v_and_b32 v15, v15, v5
    s_waitcnt vmcnt(21)
    v_mfma_f32_16x16x16_bf16 v[32:35], v[12:13], v[192:193], v[32:35]
    v_mfma_f32_16x16x16_bf16 v[36:39], v[12:13], v[194:195], v[36:39]
    v_cvt_pk_bf16_f32 v9, v88, v88
    v_and_b32 v8, v9, v4
    v_and_b32 v9, v9, v5
    s_waitcnt vmcnt(20)
    v_mfma_f32_16x16x16_bf16 v[32:35], v[14:15], v[196:197], v[32:35]
    v_mfma_f32_16x16x16_bf16 v[36:39], v[14:15], v[198:199], v[36:39]
    v_cvt_pk_bf16_f32 v11, v89, v89
    v_and_b32 v10, v11, v4
    v_and_b32 v11, v11, v5
    s_waitcnt vmcnt(19)
    v_mfma_f32_16x16x16_bf16 v[32:35], v[8:9], v[200:201], v[32:35]
    v_mfma_f32_16x16x16_bf16 v[36:39], v[8:9], v[202:203], v[36:39]
    v_cvt_pk_bf16_f32 v13, v90, v90
    v_and_b32 v12, v13, v4
    v_and_b32 v13, v13, v5
    s_waitcnt vmcnt(18)
    v_mfma_f32_16x16x16_bf16 v[32:35], v[10:11], v[204:205], v[32:35]
    v_mfma_f32_16x16x16_bf16 v[36:39], v[10:11], v[206:207], v[36:39]
    v_cvt_pk_bf16_f32 v15, v91, v91
    v_and_b32 v14, v15, v4
    v_and_b32 v15, v15, v5
    s_waitcnt vmcnt(17)
    v_mfma_f32_16x16x16_bf16 v[32:35], v[12:13], v[208:209], v[32:35]
    v_mfma_f32_16x16x16_bf16 v[36:39], v[12:13], v[210:211], v[36:39]
    v_cvt_pk_bf16_f32 v9, v92, v92
    v_and_b32 v8, v9, v4
    v_and_b32 v9, v9, v5
    s_waitcnt vmcnt(16)
    v_mfma_f32_16x16x16_bf16 v[32:35], v[14:15], v[212:213], v[32:35]
    v_mfma_f32_16x16x16_bf16 v[36:39], v[14:15], v[214:215], v[36:39]
    v_cvt_pk_bf16_f32 v11, v93, v93
    v_and_b32 v10, v11, v4
    v_and_b32 v11, v11, v5
    s_waitcnt vmcnt(15)
    v_mfma_f32_16x16x16_bf16 v[32:35], v[8:9], v[216:217], v[32:35]
    v_mfma_f32_16x16x16_bf16 v[36:39], v[8:9], v[218:219], v[36:39]
    v_cvt_pk_bf16_f32 v13, v94, v94
    v_and_b32 v12, v13, v4
    v_and_b32 v13, v13, v5
    s_waitcnt vmcnt(14)
    v_mfma_f32_16x16x16_bf16 v[32:35], v[10:11], v[220:221], v[32:35]
    v_mfma_f32_16x16x16_bf16 v[36:39], v[10:11], v[222:223], v[36:39]
    v_cvt_pk_bf16_f32 v15, v95, v95
    v_and_b32 v14, v15, v4
    v_and_b32 v15, v15, v5
    s_waitcnt vmcnt(13)
    v_mfma_f32_16x16x16_bf16 v[32:35], v[12:13], v[224:225], v[32:35]
    v_mfma_f32_16x16x16_bf16 v[36:39], v[12:13], v[226:227], v[36:39]
    v_cvt_pk_bf16_f32 v9, v96, v96
    v_and_b32 v8, v9, v4
    v_and_b32 v9, v9, v5
    s_waitcnt vmcnt(12)
    v_mfma_f32_16x16x16_bf16 v[32:35], v[14:15], v[228:229], v[32:35]
    v_mfma_f32_16x16x16_bf16 v[36:39], v[14:15], v[230:231], v[36:39]
    v_cvt_pk_bf16_f32 v11, v97, v97
    v_and_b32 v10, v11, v4
    v_and_b32 v11, v11, v5
    s_waitcnt vmcnt(11)
    v_mfma_f32_16x16x16_bf16 v[32:35], v[8:9], v[108:109], v[32:35]
    v_mfma_f32_16x16x16_bf16 v[36:39], v[8:9], v[110:111], v[36:39]
    v_cvt_pk_bf16_f32 v13, v98, v98
    v_and_b32 v12, v13, v4
    v_and_b32 v13, v13, v5
    s_waitcnt vmcnt(10)
    v_mfma_f32_16x16x16_bf16 v[32:35], v[10:11], v[112:113], v[32:35]
    v_mfma_f32_16x16x16_bf16 v[36:39], v[10:11], v[114:115], v[36:39]
    v_cvt_pk_bf16_f32 v15, v99, v99
    v_and_b32 v14, v15, v4
    v_and_b32 v15, v15, v5
    s_waitcnt vmcnt(9)
    v_mfma_f32_16x16x16_bf16 v[32:35], v[12:13], v[116:117], v[32:35]
    v_mfma_f32_16x16x16_bf16 v[36:39], v[12:13], v[118:119], v[36:39]
    v_cvt_pk_bf16_f32 v9, v100, v100
    v_and_b32 v8, v9, v4
    v_and_b32 v9, v9, v5
    s_waitcnt vmcnt(8)
    v_mfma_f32_16x16x16_bf16 v[32:35], v[14:15], v[120:121], v[32:35]
    v_mfma_f32_16x16x16_bf16 v[36:39], v[14:15], v[122:123], v[36:39]
    v_cvt_pk_bf16_f32 v11, v101, v101
    v_and_b32 v10, v11, v4
    v_and_b32 v11, v11, v5
    s_waitcnt vmcnt(7)
    v_mfma_f32_16x16x16_bf16 v[32:35], v[8:9], v[124:125], v[32:35]
    v_mfma_f32_16x16x16_bf16 v[36:39], v[8:9], v[126:127], v[36:39]
    v_cvt_pk_bf16_f32 v13, v102, v102
    v_and_b32 v12, v13, v4
    v_and_b32 v13, v13, v5
    s_waitcnt vmcnt(6)
    v_mfma_f32_16x16x16_bf16 v[32:35], v[10:11], v[128:129], v[32:35]
    v_mfma_f32_16x16x16_bf16 v[36:39], v[10:11], v[130:131], v[36:39]
    v_cvt_pk_bf16_f32 v15, v103, v103
    v_and_b32 v14, v15, v4
    v_and_b32 v15, v15, v5
    s_waitcnt vmcnt(5)
    v_mfma_f32_16x16x16_bf16 v[32:35], v[12:13], v[132:133], v[32:35]
    v_mfma_f32_16x16x16_bf16 v[36:39], v[12:13], v[134:135], v[36:39]
    v_cvt_pk_bf16_f32 v9, v104, v104
    v_and_b32 v8, v9, v4
    v_and_b32 v9, v9, v5
    s_waitcnt vmcnt(4)
    v_mfma_f32_16x16x16_bf16 v[32:35], v[14:15], v[136:137], v[32:35]
    v_mfma_f32_16x16x16_bf16 v[36:39], v[14:15], v[138:139], v[36:39]
    v_cvt_pk_bf16_f32 v11, v105, v105
    v_and_b32 v10, v11, v4
    v_and_b32 v11, v11, v5
    s_waitcnt vmcnt(3)
    v_mfma_f32_16x16x16_bf16 v[32:35], v[8:9], v[140:141], v[32:35]
    v_mfma_f32_16x16x16_bf16 v[36:39], v[8:9], v[142:143], v[36:39]
    v_cvt_pk_bf16_f32 v13, v106, v106
    v_and_b32 v12, v13, v4
    v_and_b32 v13, v13, v5
    s_waitcnt vmcnt(2)
    v_mfma_f32_16x16x16_bf16 v[32:35], v[10:11], v[144:145], v[32:35]
    v_mfma_f32_16x16x16_bf16 v[36:39], v[10:11], v[146:147], v[36:39]
    v_cvt_pk_bf16_f32 v15, v107, v107
    v_and_b32 v14, v15, v4
    v_and_b32 v15, v15, v5
    s_waitcnt vmcnt(1)
    v_mfma_f32_16x16x16_bf16 v[32:35], v[12:13], v[148:149], v[32:35]
    v_mfma_f32_16x16x16_bf16 v[36:39], v[12:13], v[150:151], v[36:39]
    s_nop 1
    s_waitcnt vmcnt(0)
    v_mfma_f32_16x16x16_bf16 v[32:35], v[14:15], v[152:153], v[32:35]
    v_mfma_f32_16x16x16_bf16 v[36:39], v[14:15], v[154:155], v[36:39]
    s_branch L_TAIL
L_MAINP:
    s_waitcnt vmcnt(27)
    v_mfma_f32_16x16x32_bf16 v[40:43], v[108:111], v[16:19], 0
    v_mfma_f32_16x16x32_bf16 v[24:27], v[116:119], v[16:19], 0
    v_mfma_f32_16x16x32_bf16 v[40:43], v[112:115], v[20:23], v[40:43]
    v_mfma_f32_16x16x32_bf16 v[24:27], v[120:123], v[20:23], v[24:27]
    buffer_load_dwordx4 v[108:111], v2, s[8:11], s48 offen offset:2176 nt
    s_mov_b32 s48, 32768
    buffer_load_dwordx4 v[112:115], v2, s[8:11], s48 offen offset:0 nt
    buffer_load_dwordx4 v[116:119], v2, s[8:11], s48 offen offset:128 nt
    buffer_load_dwordx4 v[120:123], v2, s[8:11], s48 offen offset:2048 nt
    s_waitcnt vmcnt(27)
    v_mfma_f32_16x16x32_bf16 v[44:47], v[124:127], v[16:19], 0
    v_mfma_f32_16x16x32_bf16 v[28:31], v[132:135], v[16:19], 0
    v_mfma_f32_16x16x32_bf16 v[44:47], v[128:131], v[20:23], v[44:47]
    v_mfma_f32_16x16x32_bf16 v[28:31], v[136:139], v[20:23], v[28:31]
    buffer_load_dwordx4 v[124:127], v2, s[8:11], s48 offen offset:2176 nt
    s_mov_b32 s48, 36864
    buffer_load_dwordx4 v[128:131], v2, s[8:11], s48 offen offset:0 nt
    buffer_load_dwordx4 v[132:135], v2, s[8:11], s48 offen offset:128 nt
    buffer_load_dwordx4 v[136:139], v2, s[8:11], s48 offen offset:2048 nt
    s_nop 3
    v_permlane32_swap_b32 v40, v24
    v_permlane32_swap_b32 v41, v25
    v_permlane32_swap_b32 v42, v26
    v_permlane32_swap_b32 v43, v27
    s_nop 1
    v_mov_b32 v8, v40 quad_perm:[0,0,2,2] row_mask:0xf bank_mask:0xf
    v_mov_b32 v9, v41 quad_perm:[0,0,2,2] row_mask:0xf bank_mask:0xf
    v_mov_b32 v10, v42 quad_perm:[0,0,2,2] row_mask:0xf bank_mask:0xf
    v_mov_b32 v11, v43 quad_perm:[0,0,2,2] row_mask:0xf bank_mask:0xf
    v_add_f32 v40, v24, v8 quad_perm:[1,1,3,3] row_mask:0xf bank_mask:0xf
    v_add_f32 v41, v25, v9 quad_perm:[1,1,3,3] row_mask:0xf bank_mask:0xf
    v_add_f32 v42, v26, v10 quad_perm:[1,1,3,3] row_mask:0xf bank_mask:0xf
    v_add_f32 v43, v27, v11 quad_perm:[1,1,3,3] row_mask:0xf bank_mask:0xf
    s_waitcnt vmcnt(27)
    v_mfma_f32_16x16x32_bf16 v[48:51], v[140:143], v[16:19], 0
    v_mfma_f32_16x16x32_bf16 v[24:27], v[148:151], v[16:19], 0
    v_mfma_f32_16x16x32_bf16 v[48:51], v[144:147], v[20:23], v[48:51]
    v_mfma_f32_16x16x32_bf16 v[24:27], v[152:155], v[20:23], v[24:27]
    buffer_load_dwordx4 v[140:143], v2, s[8:11], s48 offen offset:2176 nt
    s_mov_b32 s48, 40960
    buffer_load_dwordx4 v[144:147], v2, s[8:11], s48 offen offset:0 nt
    buffer_load_dwordx4 v[148:151], v2, s[8:11], s48 offen offset:128 nt
    buffer_load_dwordx4 v[152:155], v2, s[8:11], s48 offen offset:2048 nt
    s_nop 3
    v_permlane32_swap_b32 v44, v28
    v_permlane32_swap_b32 v45, v29
    v_permlane32_swap_b32 v46, v30
    v_permlane32_swap_b32 v47, v31
    s_nop 1
    v_mov_b32 v8, v44 quad_perm:[0,0,2,2] row_mask:0xf bank_mask:0xf
    v_mov_b32 v9, v45 quad_perm:[0,0,2,2] row_mask:0xf bank_mask:0xf
    v_mov_b32 v10, v46 quad_perm:[0,0,2,2] row_mask:0xf bank_mask:0xf
    v_mov_b32 v11, v47 quad_perm:[0,0,2,2] row_mask:0xf bank_mask:0xf
    v_add_f32 v44, v28, v8 quad_perm:[1,1,3,3] row_mask:0xf bank_mask:0xf
    v_add_f32 v45, v29, v9 quad_perm:[1,1,3,3] row_mask:0xf bank_mask:0xf
    v_add_f32 v46, v30, v10 quad_perm:[1,1,3,3] row_mask:0xf bank_mask:0xf
    v_add_f32 v47, v31, v11 quad_perm:[1,1,3,3] row_mask:0xf bank_mask:0xf
    s_waitcnt vmcnt(27)
    v_mfma_f32_16x16x32_bf16 v[52:55], v[156:159], v[16:19], 0
    v_mfma_f32_16x16x32_bf16 v[28:31], v[164:167], v[16:19], 0
    v_mfma_f32_16x16x32_bf16 v[52:55], v[160:163], v[20:23], v[52:55]
    v_mfma_f32_16x16x32_bf16 v[28:31], v[168:171], v[20:23], v[28:31]
    buffer_load_dwordx4 v[156:159], v2, s[8:11], s48 offen offset:2176 nt
    s_mov_b32 s48, 45056
    buffer_load_dwordx4 v[160:163], v2, s[8:11], s48 offen offset:0 nt
    buffer_load_dwordx4 v[164:167], v2, s[8:11], s48 offen offset:128 nt
    buffer_load_dwordx4 v[168:171], v2, s[8:11], s48 offen offset:2048 nt
    s_nop 3
    v_permlane32_swap_b32 v48, v24
    v_permlane32_swap_b32 v49, v25
    v_permlane32_swap_b32 v50, v26
    v_permlane32_swap_b32 v51, v27
    s_nop 1
    v_mov_b32 v8, v48 quad_perm:[0,0,2,2] row_mask:0xf bank_mask:0xf
    v_mov_b32 v9, v49 quad_perm:[0,0,2,2] row_mask:0xf bank_mask:0xf
    v_mov_b32 v10, v50 quad_perm:[0,0,2,2] row_mask:0xf bank_mask:0xf
    v_mov_b32 v11, v51 quad_perm:[0,0,2,2] row_mask:0xf bank_mask:0xf
    v_add_f32 v48, v24, v8 quad_perm:[1,1,3,3] row_mask:0xf bank_mask:0xf
    v_add_f32 v49, v25, v9 quad_perm:[1,1,3,3] row_mask:0xf bank_mask:0xf
    v_add_f32 v50, v26, v10 quad_perm:[1,1,3,3] row_mask:0xf bank_mask:0xf
    v_add_f32 v51, v27, v11 quad_perm:[1,1,3,3] row_mask:0xf bank_mask:0xf
    s_waitcnt vmcnt(27)
    v_mfma_f32_16x16x32_bf16 v[56:59], v[172:175], v[16:19], 0
    v_mfma_f32_16x16x32_bf16 v[24:27], v[180:183], v[16:19], 0
    v_mfma_f32_16x16x32_bf16 v[56:59], v[176:179], v[20:23], v[56:59]
    v_mfma_f32_16x16x32_bf16 v[24:27], v[184:187], v[20:23], v[24:27]
    buffer_load_dwordx4 v[172:175], v2, s[8:11], s48 offen offset:2176 nt
    s_mov_b32 s48, 49152
    buffer_load_dwordx4 v[176:179], v2, s[8:11], s48 offen offset:0 nt
    buffer_load_dwordx4 v[180:183], v2, s[8:11], s48 offen offset:128 nt
    buffer_load_dwordx4 v[184:187], v2, s[8:11], s48 offen offset:2048 nt
    s_nop 3
    v_permlane32_swap_b32 v52, v28
    v_permlane32_swap_b32 v53, v29
    v_permlane32_swap_b32 v54, v30
    v_permlane32_swap_b32 v55, v31
    s_nop 1
    v_mov_b32 v8, v52 quad_perm:[0,0,2,2] row_mask:0xf bank_mask:0xf
    v_mov_b32 v9, v53 quad_perm:[0,0,2,2] row_mask:0xf bank_mask:0xf
    v_mov_b32 v10, v54 quad_perm:[0,0,2,2] row_mask:0xf bank_mask:0xf
    v_mov_b32 v11, v55 quad_perm:[0,0,2,2] row_mask:0xf bank_mask:0xf
    v_add_f32 v52, v28, v8 quad_perm:[1,1,3,3] row_mask:0xf bank_mask:0xf
    v_add_f32 v53, v29, v9 quad_perm:[1,1,3,3] row_mask:0xf bank_mask:0xf
    v_add_f32 v54, v30, v10 quad_perm:[1,1,3,3] row_mask:0xf bank_mask:0xf
    v_add_f32 v55, v31, v11 quad_perm:[1,1,3,3] row_mask:0xf bank_mask:0xf
    s_waitcnt vmcnt(27)
    v_mfma_f32_16x16x32_bf16 v[60:63], v[188:191], v[16:19], 0
    v_mfma_f32_16x16x32_bf16 v[28:31], v[196:199], v[16:19], 0
    v_mfma_f32_16x16x32_bf16 v[60:63], v[192:195], v[20:23], v[60:63]
    v_mfma_f32_16x16x32_bf16 v[28:31], v[200:203], v[20:23], v[28:31]
    buffer_load_dwordx4 v[188:191], v2, s[8:11], s48 offen offset:2176 nt
    s_mov_b32 s48, 53248
    buffer_load_dwordx4 v[192:195], v2, s[8:11], s48 offen offset:0 nt
    buffer_load_dwordx4 v[196:199], v2, s[8:11], s48 offen offset:128 nt
    buffer_load_dwordx4 v[200:203], v2, s[8:11], s48 offen offset:2048 nt
    s_nop 3
    v_permlane32_swap_b32 v56, v24
    v_permlane32_swap_b32 v57, v25
    v_permlane32_swap_b32 v58, v26
    v_permlane32_swap_b32 v59, v27
    s_nop 1
    v_mov_b32 v8, v56 quad_perm:[0,0,2,2] row_mask:0xf bank_mask:0xf
    v_mov_b32 v9, v57 quad_perm:[0,0,2,2] row_mask:0xf bank_mask:0xf
    v_mov_b32 v10, v58 quad_perm:[0,0,2,2] row_mask:0xf bank_mask:0xf
    v_mov_b32 v11, v59 quad_perm:[0,0,2,2] row_mask:0xf bank_mask:0xf
    v_add_f32 v56, v24, v8 quad_perm:[1,1,3,3] row_mask:0xf bank_mask:0xf
    v_add_f32 v57, v25, v9 quad_perm:[1,1,3,3] row_mask:0xf bank_mask:0xf
    v_add_f32 v58, v26, v10 quad_perm:[1,1,3,3] row_mask:0xf bank_mask:0xf
    v_add_f32 v59, v27, v11 quad_perm:[1,1,3,3] row_mask:0xf bank_mask:0xf
    s_waitcnt vmcnt(27)
    v_mfma_f32_16x16x32_bf16 v[64:67], v[204:207], v[16:19], 0
    v_mfma_f32_16x16x32_bf16 v[24:27], v[212:215], v[16:19], 0
    v_mfma_f32_16x16x32_bf16 v[64:67], v[208:211], v[20:23], v[64:67]
    v_mfma_f32_16x16x32_bf16 v[24:27], v[216:219], v[20:23], v[24:27]
    buffer_load_dwordx4 v[204:207], v2, s[8:11], s48 offen offset:2176 nt
    s_mov_b32 s49, 0
    buffer_load_dwordx4 v[208:211], v3, s[12:15], s49 offen offset:0 nt
    buffer_load_dwordx4 v[212:215], v3, s[12:15], s49 offen offset:256 nt
    buffer_load_dwordx4 v[216:219], v3, s[12:15], s49 offen offset:512 nt
    s_nop 3
    v_permlane32_swap_b32 v60, v28
    v_permlane32_swap_b32 v61, v29
    v_permlane32_swap_b32 v62, v30
    v_permlane32_swap_b32 v63, v31
    s_nop 1
    v_mov_b32 v8, v60 quad_perm:[0,0,2,2] row_mask:0xf bank_mask:0xf
    v_mov_b32 v9, v61 quad_perm:[0,0,2,2] row_mask:0xf bank_mask:0xf
    v_mov_b32 v10, v62 quad_perm:[0,0,2,2] row_mask:0xf bank_mask:0xf
    v_mov_b32 v11, v63 quad_perm:[0,0,2,2] row_mask:0xf bank_mask:0xf
    v_add_f32 v60, v28, v8 quad_perm:[1,1,3,3] row_mask:0xf bank_mask:0xf
    v_add_f32 v61, v29, v9 quad_perm:[1,1,3,3] row_mask:0xf bank_mask:0xf
    v_add_f32 v62, v30, v10 quad_perm:[1,1,3,3] row_mask:0xf bank_mask:0xf
    v_add_f32 v63, v31, v11 quad_perm:[1,1,3,3] row_mask:0xf bank_mask:0xf
    s_waitcnt vmcnt(27)
    v_mfma_f32_16x16x32_bf16 v[68:71], v[220:223], v[16:19], 0
    v_mfma_f32_16x16x32_bf16 v[28:31], v[228:231], v[16:19], 0
    v_mfma_f32_16x16x32_bf16 v[68:71], v[224:227], v[20:23], v[68:71]
    v_mfma_f32_16x16x32_bf16 v[28:31], v[108:111], v[20:23], v[28:31]
    buffer_load_dwordx4 v[220:223], v3, s[12:15], s49 offen offset:768 nt
    s_mov_b32 s49, 4096
    buffer_load_dwordx4 v[224:227], v3, s[12:15], s49 offen offset:0 nt
    buffer_load_dwordx4 v[228:231], v3, s[12:15], s49 offen offset:256 nt
    buffer_load_dwordx4 v[108:111], v3, s[12:15], s49 offen offset:512 nt
    s_nop 3
    v_permlane32_swap_b32 v64, v24
    v_permlane32_swap_b32 v65, v25
    v_permlane32_swap_b32 v66, v26
    v_permlane32_swap_b32 v67, v27
    s_nop 1
    v_mov_b32 v8, v64 quad_perm:[0,0,2,2] row_mask:0xf bank_mask:0xf
    v_mov_b32 v9, v65 quad_perm:[0,0,2,2] row_mask:0xf bank_mask:0xf
    v_mov_b32 v10, v66 quad_perm:[0,0,2,2] row_mask:0xf bank_mask:0xf
    v_mov_b32 v11, v67 quad_perm:[0,0,2,2] row_mask:0xf bank_mask:0xf
    v_add_f32 v64, v24, v8 quad_perm:[1,1,3,3] row_mask:0xf bank_mask:0xf
    v_add_f32 v65, v25, v9 quad_perm:[1,1,3,3] row_mask:0xf bank_mask:0xf
    v_add_f32 v66, v26, v10 quad_perm:[1,1,3,3] row_mask:0xf bank_mask:0xf
    v_add_f32 v67, v27, v11 quad_perm:[1,1,3,3] row_mask:0xf bank_mask:0xf
    s_waitcnt vmcnt(27)
    v_mfma_f32_16x16x32_bf16 v[72:75], v[112:115], v[16:19], 0
    v_mfma_f32_16x16x32_bf16 v[24:27], v[120:123], v[16:19], 0
    v_mfma_f32_16x16x32_bf16 v[72:75], v[116:119], v[20:23], v[72:75]
    v_mfma_f32_16x16x32_bf16 v[24:27], v[124:127], v[20:23], v[24:27]
    buffer_load_dwordx4 v[112:115], v3, s[12:15], s49 offen offset:768 nt
    s_mov_b32 s49, 8192
    buffer_load_dwordx4 v[116:119], v3, s[12:15], s49 offen offset:0 nt
    buffer_load_dwordx4 v[120:123], v3, s[12:15], s49 offen offset:256 nt
    buffer_load_dwordx4 v[124:127], v3, s[12:15], s49 offen offset:512 nt
    s_nop 3
    v_permlane32_swap_b32 v68, v28
    v_permlane32_swap_b32 v69, v29
    v_permlane32_swap_b32 v70, v30
    v_permlane32_swap_b32 v71, v31
    s_nop 1
    v_mov_b32 v8, v68 quad_perm:[0,0,2,2] row_mask:0xf bank_mask:0xf
    v_mov_b32 v9, v69 quad_perm:[0,0,2,2] row_mask:0xf bank_mask:0xf
    v_mov_b32 v10, v70 quad_perm:[0,0,2,2] row_mask:0xf bank_mask:0xf
    v_mov_b32 v11, v71 quad_perm:[0,0,2,2] row_mask:0xf bank_mask:0xf
    v_add_f32 v68, v28, v8 quad_perm:[1,1,3,3] row_mask:0xf bank_mask:0xf
    v_add_f32 v69, v29, v9 quad_perm:[1,1,3,3] row_mask:0xf bank_mask:0xf
    v_add_f32 v70, v30, v10 quad_perm:[1,1,3,3] row_mask:0xf bank_mask:0xf
    v_add_f32 v71, v31, v11 quad_perm:[1,1,3,3] row_mask:0xf bank_mask:0xf
    s_waitcnt vmcnt(27)
    v_mfma_f32_16x16x32_bf16 v[76:79], v[128:131], v[16:19], 0
    v_mfma_f32_16x16x32_bf16 v[28:31], v[136:139], v[16:19], 0
    v_mfma_f32_16x16x32_bf16 v[76:79], v[132:135], v[20:23], v[76:79]
    v_mfma_f32_16x16x32_bf16 v[28:31], v[140:143], v[20:23], v[28:31]
    buffer_load_dwordx4 v[128:131], v3, s[12:15], s49 offen offset:768 nt
    s_mov_b32 s49, 12288
    buffer_load_dwordx4 v[132:135], v3, s[12:15], s49 offen offset:0 nt
    buffer_load_dwordx4 v[136:139], v3, s[12:15], s49 offen offset:256 nt
    buffer_load_dwordx4 v[140:143], v3, s[12:15], s49 offen offset:512 nt
    s_nop 3
    v_permlane32_swap_b32 v72, v24
    v_permlane32_swap_b32 v73, v25
    v_permlane32_swap_b32 v74, v26
    v_permlane32_swap_b32 v75, v27
    s_nop 1
    v_mov_b32 v8, v72 quad_perm:[0,0,2,2] row_mask:0xf bank_mask:0xf
    v_mov_b32 v9, v73 quad_perm:[0,0,2,2] row_mask:0xf bank_mask:0xf
    v_mov_b32 v10, v74 quad_perm:[0,0,2,2] row_mask:0xf bank_mask:0xf
    v_mov_b32 v11, v75 quad_perm:[0,0,2,2] row_mask:0xf bank_mask:0xf
    v_add_f32 v72, v24, v8 quad_perm:[1,1,3,3] row_mask:0xf bank_mask:0xf
    v_add_f32 v73, v25, v9 quad_perm:[1,1,3,3] row_mask:0xf bank_mask:0xf
    v_add_f32 v74, v26, v10 quad_perm:[1,1,3,3] row_mask:0xf bank_mask:0xf
    v_add_f32 v75, v27, v11 quad_perm:[1,1,3,3] row_mask:0xf bank_mask:0xf
    s_waitcnt vmcnt(27)
    v_mfma_f32_16x16x32_bf16 v[80:83], v[144:147], v[16:19], 0
    v_mfma_f32_16x16x32_bf16 v[24:27], v[152:155], v[16:19], 0
    v_mfma_f32_16x16x32_bf16 v[80:83], v[148:151], v[20:23], v[80:83]
    v_mfma_f32_16x16x32_bf16 v[24:27], v[156:159], v[20:23], v[24:27]
    buffer_load_dwordx4 v[144:147], v3, s[12:15], s49 offen offset:768 nt
    s_mov_b32 s49, 16384
    buffer_load_dwordx4 v[148:151], v3, s[12:15], s49 offen offset:0 nt
    buffer_load_dwordx4 v[152:155], v3, s[12:15], s49 offen offset:256 nt
    buffer_load_dwordx4 v[156:159], v3, s[12:15], s49 offen offset:512 nt
    s_nop 3
    v_permlane32_swap_b32 v76, v28
    v_permlane32_swap_b32 v77, v29
    v_permlane32_swap_b32 v78, v30
    v_permlane32_swap_b32 v79, v31
    s_nop 1
    v_mov_b32 v8, v76 quad_perm:[0,0,2,2] row_mask:0xf bank_mask:0xf
    v_mov_b32 v9, v77 quad_perm:[0,0,2,2] row_mask:0xf bank_mask:0xf
    v_mov_b32 v10, v78 quad_perm:[0,0,2,2] row_mask:0xf bank_mask:0xf
    v_mov_b32 v11, v79 quad_perm:[0,0,2,2] row_mask:0xf bank_mask:0xf
    v_add_f32 v76, v28, v8 quad_perm:[1,1,3,3] row_mask:0xf bank_mask:0xf
    v_add_f32 v77, v29, v9 quad_perm:[1,1,3,3] row_mask:0xf bank_mask:0xf
    v_add_f32 v78, v30, v10 quad_perm:[1,1,3,3] row_mask:0xf bank_mask:0xf
    v_add_f32 v79, v31, v11 quad_perm:[1,1,3,3] row_mask:0xf bank_mask:0xf
    s_waitcnt vmcnt(27)
    v_mfma_f32_16x16x32_bf16 v[84:87], v[160:163], v[16:19], 0
    v_mfma_f32_16x16x32_bf16 v[28:31], v[168:171], v[16:19], 0
    v_mfma_f32_16x16x32_bf16 v[84:87], v[164:167], v[20:23], v[84:87]
    v_mfma_f32_16x16x32_bf16 v[28:31], v[172:175], v[20:23], v[28:31]
    buffer_load_dwordx4 v[160:163], v3, s[12:15], s49 offen offset:768 nt
    s_mov_b32 s49, 20480
    buffer_load_dwordx4 v[164:167], v3, s[12:15], s49 offen offset:0 nt
    buffer_load_dwordx4 v[168:171], v3, s[12:15], s49 offen offset:256 nt
    buffer_load_dwordx4 v[172:175], v3, s[12:15], s49 offen offset:512 nt
    s_nop 3
    v_permlane32_swap_b32 v80, v24
    v_permlane32_swap_b32 v81, v25
    v_permlane32_swap_b32 v82, v26
    v_permlane32_swap_b32 v83, v27
    s_nop 1
    v_mov_b32 v8, v80 quad_perm:[0,0,2,2] row_mask:0xf bank_mask:0xf
    v_mov_b32 v9, v81 quad_perm:[0,0,2,2] row_mask:0xf bank_mask:0xf
    v_mov_b32 v10, v82 quad_perm:[0,0,2,2] row_mask:0xf bank_mask:0xf
    v_mov_b32 v11, v83 quad_perm:[0,0,2,2] row_mask:0xf bank_mask:0xf
    v_add_f32 v80, v24, v8 quad_perm:[1,1,3,3] row_mask:0xf bank_mask:0xf
    v_add_f32 v81, v25, v9 quad_perm:[1,1,3,3] row_mask:0xf bank_mask:0xf
    v_add_f32 v82, v26, v10 quad_perm:[1,1,3,3] row_mask:0xf bank_mask:0xf
    v_add_f32 v83, v27, v11 quad_perm:[1,1,3,3] row_mask:0xf bank_mask:0xf
    s_waitcnt vmcnt(27)
    v_mfma_f32_16x16x32_bf16 v[88:91], v[176:179], v[16:19], 0
    v_mfma_f32_16x16x32_bf16 v[24:27], v[184:187], v[16:19], 0
    v_mfma_f32_16x16x32_bf16 v[88:91], v[180:183], v[20:23], v[88:91]
    v_mfma_f32_16x16x32_bf16 v[24:27], v[188:191], v[20:23], v[24:27]
    buffer_load_dwordx4 v[176:179], v3, s[12:15], s49 offen offset:768 nt
    s_mov_b32 s49, 24576
    buffer_load_dwordx4 v[180:183], v3, s[12:15], s49 offen offset:0 nt
    buffer_load_dwordx4 v[184:187], v3, s[12:15], s49 offen offset:256 nt
    buffer_load_dwordx4 v[188:191], v3, s[12:15], s49 offen offset:512 nt
    s_nop 3
    v_permlane32_swap_b32 v84, v28
    v_permlane32_swap_b32 v85, v29
    v_permlane32_swap_b32 v86, v30
    v_permlane32_swap_b32 v87, v31
    s_nop 1
    v_mov_b32 v8, v84 quad_perm:[0,0,2,2] row_mask:0xf bank_mask:0xf
    v_mov_b32 v9, v85 quad_perm:[0,0,2,2] row_mask:0xf bank_mask:0xf
    v_mov_b32 v10, v86 quad_perm:[0,0,2,2] row_mask:0xf bank_mask:0xf
    v_mov_b32 v11, v87 quad_perm:[0,0,2,2] row_mask:0xf bank_mask:0xf
    v_add_f32 v84, v28, v8 quad_perm:[1,1,3,3] row_mask:0xf bank_mask:0xf
    v_add_f32 v85, v29, v9 quad_perm:[1,1,3,3] row_mask:0xf bank_mask:0xf
    v_add_f32 v86, v30, v10 quad_perm:[1,1,3,3] row_mask:0xf bank_mask:0xf
    v_add_f32 v87, v31, v11 quad_perm:[1,1,3,3] row_mask:0xf bank_mask:0xf
    s_waitcnt vmcnt(27)
    v_mfma_f32_16x16x32_bf16 v[92:95], v[192:195], v[16:19], 0
    v_mfma_f32_16x16x32_bf16 v[28:31], v[200:203], v[16:19], 0
    v_mfma_f32_16x16x32_bf16 v[92:95], v[196:199], v[20:23], v[92:95]
    v_mfma_f32_16x16x32_bf16 v[28:31], v[204:207], v[20:23], v[28:31]
    buffer_load_dwordx4 v[192:195], v3, s[12:15], s49 offen offset:768 nt
    s_mov_b32 s49, 28672
    buffer_load_dwordx4 v[196:199], v3, s[12:15], s49 offen offset:0 nt
    buffer_load_dwordx4 v[200:203], v3, s[12:15], s49 offen offset:256 nt
    buffer_load_dwordx4 v[204:207], v3, s[12:15], s49 offen offset:512 nt
    s_nop 3
    v_permlane32_swap_b32 v88, v24
    v_permlane32_swap_b32 v89, v25
    v_permlane32_swap_b32 v90, v26
    v_permlane32_swap_b32 v91, v27
    s_nop 1
    v_mov_b32 v8, v88 quad_perm:[0,0,2,2] row_mask:0xf bank_mask:0xf
    v_mov_b32 v9, v89 quad_perm:[0,0,2,2] row_mask:0xf bank_mask:0xf
    v_mov_b32 v10, v90 quad_perm:[0,0,2,2] row_mask:0xf bank_mask:0xf
    v_mov_b32 v11, v91 quad_perm:[0,0,2,2] row_mask:0xf bank_mask:0xf
    v_add_f32 v88, v24, v8 quad_perm:[1,1,3,3] row_mask:0xf bank_mask:0xf
    v_add_f32 v89, v25, v9 quad_perm:[1,1,3,3] row_mask:0xf bank_mask:0xf
    v_add_f32 v90, v26, v10 quad_perm:[1,1,3,3] row_mask:0xf bank_mask:0xf
    v_add_f32 v91, v27, v11 quad_perm:[1,1,3,3] row_mask:0xf bank_mask:0xf
    s_nop 7
    s_nop 3
    v_permlane32_swap_b32 v92, v28
    v_permlane32_swap_b32 v93, v29
    v_permlane32_swap_b32 v94, v30
    v_permlane32_swap_b32 v95, v31
    s_nop 1
    v_mov_b32 v8, v92 quad_perm:[0,0,2,2] row_mask:0xf bank_mask:0xf
    v_mov_b32 v9, v93 quad_perm:[0,0,2,2] row_mask:0xf bank_mask:0xf
    v_mov_b32 v10, v94 quad_perm:[0,0,2,2] row_mask:0xf bank_mask:0xf
    v_mov_b32 v11, v95 quad_perm:[0,0,2,2] row_mask:0xf bank_mask:0xf
    v_add_f32 v92, v28, v8 quad_perm:[1,1,3,3] row_mask:0xf bank_mask:0xf
    v_add_f32 v93, v29, v9 quad_perm:[1,1,3,3] row_mask:0xf bank_mask:0xf
    v_add_f32 v94, v30, v10 quad_perm:[1,1,3,3] row_mask:0xf bank_mask:0xf
    v_add_f32 v95, v31, v11 quad_perm:[1,1,3,3] row_mask:0xf bank_mask:0xf
    s_lshl_b32 s50, s4, 19
    s_lshl_b32 s53, s6, 15
    s_add_u32 s50, s50, s53
    v_lshlrev_b32 v6, 1, v0
    s_add_u32 s53, s50, 0
    buffer_load_ushort v232, v6, s[20:23], s53 offen offset:0
    buffer_load_ushort v16, v6, s[20:23], s53 offen offset:1024
    buffer_load_ushort v233, v6, s[20:23], s53 offen offset:2048
    buffer_load_ushort v17, v6, s[20:23], s53 offen offset:3072
    s_add_u32 s53, s50, 4096
    buffer_load_ushort v234, v6, s[20:23], s53 offen offset:0
    buffer_load_ushort v18, v6, s[20:23], s53 offen offset:1024
    buffer_load_ushort v235, v6, s[20:23], s53 offen offset:2048
    buffer_load_ushort v19, v6, s[20:23], s53 offen offset:3072
    s_add_u32 s53, s50, 8192
    buffer_load_ushort v236, v6, s[20:23], s53 offen offset:0
    buffer_load_ushort v20, v6, s[20:23], s53 offen offset:1024
    buffer_load_ushort v237, v6, s[20:23], s53 offen offset:2048
    buffer_load_ushort v21, v6, s[20:23], s53 offen offset:3072
    s_add_u32 s53, s50, 12288
    buffer_load_ushort v238, v6, s[20:23], s53 offen offset:0
    buffer_load_ushort v22, v6, s[20:23], s53 offen offset:1024
    buffer_load_ushort v239, v6, s[20:23], s53 offen offset:2048
    buffer_load_ushort v23, v6, s[20:23], s53 offen offset:3072
    s_add_u32 s53, s50, 16384
    buffer_load_ushort v240, v6, s[20:23], s53 offen offset:0
    buffer_load_ushort v24, v6, s[20:23], s53 offen offset:1024
    buffer_load_ushort v241, v6, s[20:23], s53 offen offset:2048
    buffer_load_ushort v25, v6, s[20:23], s53 offen offset:3072
    s_add_u32 s53, s50, 20480
    buffer_load_ushort v242, v6, s[20:23], s53 offen offset:0
    buffer_load_ushort v26, v6, s[20:23], s53 offen offset:1024
    buffer_load_ushort v243, v6, s[20:23], s53 offen offset:2048
    buffer_load_ushort v27, v6, s[20:23], s53 offen offset:3072
    s_add_u32 s53, s50, 24576
    buffer_load_ushort v244, v6, s[20:23], s53 offen offset:0
    buffer_load_ushort v28, v6, s[20:23], s53 offen offset:1024
    buffer_load_ushort v245, v6, s[20:23], s53 offen offset:2048
    buffer_load_ushort v29, v6, s[20:23], s53 offen offset:3072
    s_add_u32 s53, s50, 28672
    buffer_load_ushort v246, v6, s[20:23], s53 offen offset:0
    buffer_load_ushort v30, v6, s[20:23], s53 offen offset:1024
    buffer_load_ushort v247, v6, s[20:23], s53 offen offset:2048
    buffer_load_ushort v31, v6, s[20:23], s53 offen offset:3072
    v_mov_b32 v7, 0
    s_lshl_b32 s50, s5, 10
    s_lshl_b32 s53, s51, 3
    s_add_u32 s50, s50, s53
    buffer_load_dwordx2 v[250:251], v7, s[24:27], s50 offen
    s_nop 7
    v_max3_f32 v8, v40, v41, v42
    v_max3_f32 v9, v43, v44, v45
    v_max3_f32 v8, v8, v46, v47
    v_max3_f32 v9, v9, v48, v49
    v_max3_f32 v8, v8, v50, v51
    v_max3_f32 v9, v9, v52, v53
    v_max3_f32 v8, v8, v54, v55
    v_max3_f32 v9, v9, v56, v57
    v_max3_f32 v8, v8, v58, v59
    v_max3_f32 v9, v9, v60, v61
    v_max3_f32 v8, v8, v62, v63
    v_max3_f32 v9, v9, v64, v65
    v_max3_f32 v8, v8, v66, v67
    v_max3_f32 v9, v9, v68, v69
    v_max3_f32 v8, v8, v70, v71
    v_max3_f32 v9, v9, v72, v73
    v_max3_f32 v8, v8, v74, v75
    v_max3_f32 v9, v9, v76, v77
    v_max3_f32 v8, v8, v78, v79
    v_max3_f32 v9, v9, v80, v81
    v_max3_f32 v8, v8, v82, v83
    v_max3_f32 v9, v9, v84, v85
    v_max3_f32 v8, v8, v86, v87
    v_max3_f32 v9, v9, v88, v89
    v_max3_f32 v8, v8, v90, v91
    v_max3_f32 v9, v9, v92, v93
    v_max3_f32 v8, v8, v94, v95
    v_max_f32 v8, v8, v9
    v_mov_b32 v9, v8
    s_nop 1
    v_permlane16_swap_b32 v8, v9
    s_nop 1
    v_max_f32 v8, v8, v9
    v_mov_b32 v9, v8
    s_nop 1
    v_permlane32_swap_b32 v8, v9
    s_nop 1
    v_max_f32 v8, v8, v9
    v_mov_b32 v249, v8
    v_mul_f32 v10, s52, v8
    v_sub_f32 v10, 0, v10
    v_fma_f32 v40, v40, s52, v10
    v_fma_f32 v41, v41, s52, v10
    v_fma_f32 v42, v42, s52, v10
    v_fma_f32 v43, v43, s52, v10
    v_fma_f32 v44, v44, s52, v10
    v_fma_f32 v45, v45, s52, v10
    v_fma_f32 v46, v46, s52, v10
    v_fma_f32 v47, v47, s52, v10
    v_fma_f32 v48, v48, s52, v10
    v_fma_f32 v49, v49, s52, v10
    v_fma_f32 v50, v50, s52, v10
    v_fma_f32 v51, v51, s52, v10
    v_fma_f32 v52, v52, s52, v10
    v_fma_f32 v53, v53, s52, v10
    v_fma_f32 v54, v54, s52, v10
    v_fma_f32 v55, v55, s52, v10
    v_fma_f32 v56, v56, s52, v10
    v_fma_f32 v57, v57, s52, v10
    v_fma_f32 v58, v58, s52, v10
    v_fma_f32 v59, v59, s52, v10
    v_fma_f32 v60, v60, s52, v10
    v_fma_f32 v61, v61, s52, v10
    v_fma_f32 v62, v62, s52, v10
    v_fma_f32 v63, v63, s52, v10
    v_fma_f32 v64, v64, s52, v10
    v_fma_f32 v65, v65, s52, v10
    v_fma_f32 v66, v66, s52, v10
    v_fma_f32 v67, v67, s52, v10
    v_fma_f32 v68, v68, s52, v10
    v_fma_f32 v69, v69, s52, v10
    v_fma_f32 v70, v70, s52, v10
    v_fma_f32 v71, v71, s52, v10
    v_fma_f32 v72, v72, s52, v10
    v_fma_f32 v73, v73, s52, v10
    v_fma_f32 v74, v74, s52, v10
    v_fma_f32 v75, v75, s52, v10
    v_fma_f32 v76, v76, s52, v10
    v_fma_f32 v77, v77, s52, v10
    v_fma_f32 v78, v78, s52, v10
    v_fma_f32 v79, v79, s52, v10
    v_fma_f32 v80, v80, s52, v10
    v_fma_f32 v81, v81, s52, v10
    v_fma_f32 v82, v82, s52, v10
    v_fma_f32 v83, v83, s52, v10
    v_fma_f32 v84, v84, s52, v10
    v_fma_f32 v85, v85, s52, v10
    v_fma_f32 v86, v86, s52, v10
    v_fma_f32 v87, v87, s52, v10
    v_fma_f32 v88, v88, s52, v10
    v_fma_f32 v89, v89, s52, v10
    v_fma_f32 v90, v90, s52, v10
    v_fma_f32 v91, v91, s52, v10
    v_fma_f32 v92, v92, s52, v10
    v_fma_f32 v93, v93, s52, v10
    v_fma_f32 v94, v94, s52, v10
    v_fma_f32 v95, v95, s52, v10
    v_exp_f32 v40, v40
    v_exp_f32 v41, v41
    v_exp_f32 v42, v42
    v_exp_f32 v43, v43
    v_exp_f32 v44, v44
    v_exp_f32 v45, v45
    v_exp_f32 v46, v46
    v_exp_f32 v47, v47
    v_exp_f32 v48, v48
    v_exp_f32 v49, v49
    v_exp_f32 v50, v50
    v_exp_f32 v51, v51
    v_exp_f32 v52, v52
    v_exp_f32 v53, v53
    v_exp_f32 v54, v54
    v_exp_f32 v55, v55
    v_exp_f32 v56, v56
    v_exp_f32 v57, v57
    v_exp_f32 v58, v58
    v_exp_f32 v59, v59
    v_exp_f32 v60, v60
    v_exp_f32 v61, v61
    v_exp_f32 v62, v62
    v_exp_f32 v63, v63
    v_exp_f32 v64, v64
    v_exp_f32 v65, v65
    v_exp_f32 v66, v66
    v_exp_f32 v67, v67
    v_exp_f32 v68, v68
    v_exp_f32 v69, v69
    v_exp_f32 v70, v70
    v_exp_f32 v71, v71
    v_exp_f32 v72, v72
    v_exp_f32 v73, v73
    v_exp_f32 v74, v74
    v_exp_f32 v75, v75
    v_exp_f32 v76, v76
    v_exp_f32 v77, v77
    v_exp_f32 v78, v78
    v_exp_f32 v79, v79
    v_exp_f32 v80, v80
    v_exp_f32 v81, v81
    v_exp_f32 v82, v82
    v_exp_f32 v83, v83
    v_exp_f32 v84, v84
    v_exp_f32 v85, v85
    v_exp_f32 v86, v86
    v_exp_f32 v87, v87
    v_exp_f32 v88, v88
    v_exp_f32 v89, v89
    v_exp_f32 v90, v90
    v_exp_f32 v91, v91
    v_exp_f32 v92, v92
    v_exp_f32 v93, v93
    v_exp_f32 v94, v94
    v_exp_f32 v95, v95
    s_nop 0
    v_add_f32 v12, v40, v44
    v_add_f32 v13, v41, v45
    v_add_f32 v14, v42, v46
    v_add_f32 v15, v43, v47
    v_add_f32 v12, v12, v48
    v_add_f32 v13, v13, v49
    v_add_f32 v14, v14, v50
    v_add_f32 v15, v15, v51
    v_add_f32 v12, v12, v52
    v_add_f32 v13, v13, v53
    v_add_f32 v14, v14, v54
    v_add_f32 v15, v15, v55
    v_add_f32 v12, v12, v56
    v_add_f32 v13, v13, v57
    v_add_f32 v14, v14, v58
    v_add_f32 v15, v15, v59
    v_add_f32 v12, v12, v60
    v_add_f32 v13, v13, v61
    v_add_f32 v14, v14, v62
    v_add_f32 v15, v15, v63
    v_add_f32 v12, v12, v64
    v_add_f32 v13, v13, v65
    v_add_f32 v14, v14, v66
    v_add_f32 v15, v15, v67
    v_add_f32 v12, v12, v68
    v_add_f32 v13, v13, v69
    v_add_f32 v14, v14, v70
    v_add_f32 v15, v15, v71
    v_add_f32 v12, v12, v72
    v_add_f32 v13, v13, v73
    v_add_f32 v14, v14, v74
    v_add_f32 v15, v15, v75
    v_add_f32 v12, v12, v76
    v_add_f32 v13, v13, v77
    v_add_f32 v14, v14, v78
    v_add_f32 v15, v15, v79
    v_add_f32 v12, v12, v80
    v_add_f32 v13, v13, v81
    v_add_f32 v14, v14, v82
    v_add_f32 v15, v15, v83
    v_add_f32 v12, v12, v84
    v_add_f32 v13, v13, v85
    v_add_f32 v14, v14, v86
    v_add_f32 v15, v15, v87
    v_add_f32 v12, v12, v88
    v_add_f32 v13, v13, v89
    v_add_f32 v14, v14, v90
    v_add_f32 v15, v15, v91
    v_add_f32 v12, v12, v92
    v_add_f32 v13, v13, v93
    v_add_f32 v14, v14, v94
    v_add_f32 v15, v15, v95
    v_add_f32 v12, v12, v13
    v_add_f32 v14, v14, v15
    v_add_f32 v12, v12, v14
    v_mov_b32 v13, v12
    s_nop 1
    v_permlane16_swap_b32 v12, v13
    s_nop 1
    v_add_f32 v12, v12, v13
    v_mov_b32 v13, v12
    s_nop 1
    v_permlane32_swap_b32 v12, v13
    s_nop 1
    v_add_f32 v12, v12, v13
    v_mov_b32 v252, v12
    v_cvt_pk_bf16_f32 v9, v40, v40
    v_and_b32 v8, v9, v4
    v_and_b32 v9, v9, v5
    v_cvt_pk_bf16_f32 v11, v41, v41
    v_and_b32 v10, v11, v4
    v_and_b32 v11, v11, v5
    s_waitcnt vmcnt(63)
    v_mfma_f32_16x16x16_bf16 v[32:35], v[8:9], v[208:209], 0
    v_mfma_f32_16x16x16_bf16 v[36:39], v[8:9], v[210:211], 0
    buffer_load_dwordx4 v[208:211], v3, s[12:15], s49 offen offset:768 nt
    v_cvt_pk_bf16_f32 v13, v42, v42
    v_and_b32 v12, v13, v4
    v_and_b32 v13, v13, v5
    s_waitcnt vmcnt(63)
    v_mfma_f32_16x16x16_bf16 v[32:35], v[10:11], v[212:213], v[32:35]
    v_mfma_f32_16x16x16_bf16 v[36:39], v[10:11], v[214:215], v[36:39]
    s_mov_b32 s49, 32768
    buffer_load_dwordx4 v[212:215], v3, s[12:15], s49 offen offset:0 nt
    v_cvt_pk_bf16_f32 v15, v43, v43
    v_and_b32 v14, v15, v4
    v_and_b32 v15, v15, v5
    s_waitcnt vmcnt(63)
    v_mfma_f32_16x16x16_bf16 v[32:35], v[12:13], v[216:217], v[32:35]
    v_mfma_f32_16x16x16_bf16 v[36:39], v[12:13], v[218:219], v[36:39]
    buffer_load_dwordx4 v[216:219], v3, s[12:15], s49 offen offset:256 nt
    v_cvt_pk_bf16_f32 v9, v44, v44
    v_and_b32 v8, v9, v4
    v_and_b32 v9, v9, v5
    s_waitcnt vmcnt(63)
    v_mfma_f32_16x16x16_bf16 v[32:35], v[14:15], v[220:221], v[32:35]
    v_mfma_f32_16x16x16_bf16 v[36:39], v[14:15], v[222:223], v[36:39]
    buffer_load_dwordx4 v[220:223], v3, s[12:15], s49 offen offset:512 nt
    v_cvt_pk_bf16_f32 v11, v45, v45
    v_and_b32 v10, v11, v4
    v_and_b32 v11, v11, v5
    s_waitcnt vmcnt(63)
    v_mfma_f32_16x16x16_bf16 v[32:35], v[8:9], v[224:225], v[32:35]
    v_mfma_f32_16x16x16_bf16 v[36:39], v[8:9], v[226:227], v[36:39]
    buffer_load_dwordx4 v[224:227], v3, s[12:15], s49 offen offset:768 nt
    v_cvt_pk_bf16_f32 v13, v46, v46
    v_and_b32 v12, v13, v4
    v_and_b32 v13, v13, v5
    s_waitcnt vmcnt(63)
    v_mfma_f32_16x16x16_bf16 v[32:35], v[10:11], v[228:229], v[32:35]
    v_mfma_f32_16x16x16_bf16 v[36:39], v[10:11], v[230:231], v[36:39]
    s_mov_b32 s49, 36864
    buffer_load_dwordx4 v[228:231], v3, s[12:15], s49 offen offset:0 nt
    v_cvt_pk_bf16_f32 v15, v47, v47
    v_and_b32 v14, v15, v4
    v_and_b32 v15, v15, v5
    s_waitcnt vmcnt(63)
    v_mfma_f32_16x16x16_bf16 v[32:35], v[12:13], v[108:109], v[32:35]
    v_mfma_f32_16x16x16_bf16 v[36:39], v[12:13], v[110:111], v[36:39]
    buffer_load_dwordx4 v[108:111], v3, s[12:15], s49 offen offset:256 nt
    v_cvt_pk_bf16_f32 v9, v48, v48
    v_and_b32 v8, v9, v4
    v_and_b32 v9, v9, v5
    s_waitcnt vmcnt(63)
    v_mfma_f32_16x16x16_bf16 v[32:35], v[14:15], v[112:113], v[32:35]
    v_mfma_f32_16x16x16_bf16 v[36:39], v[14:15], v[114:115], v[36:39]
    buffer_load_dwordx4 v[112:115], v3, s[12:15], s49 offen offset:512 nt
    v_cvt_pk_bf16_f32 v11, v49, v49
    v_and_b32 v10, v11, v4
    v_and_b32 v11, v11, v5
    s_waitcnt vmcnt(63)
    v_mfma_f32_16x16x16_bf16 v[32:35], v[8:9], v[116:117], v[32:35]
    v_mfma_f32_16x16x16_bf16 v[36:39], v[8:9], v[118:119], v[36:39]
    buffer_load_dwordx4 v[116:119], v3, s[12:15], s49 offen offset:768 nt
    v_cvt_pk_bf16_f32 v13, v50, v50
    v_and_b32 v12, v13, v4
    v_and_b32 v13, v13, v5
    s_waitcnt vmcnt(63)
    v_mfma_f32_16x16x16_bf16 v[32:35], v[10:11], v[120:121], v[32:35]
    v_mfma_f32_16x16x16_bf16 v[36:39], v[10:11], v[122:123], v[36:39]
    s_mov_b32 s49, 40960
    buffer_load_dwordx4 v[120:123], v3, s[12:15], s49 offen offset:0 nt
    v_cvt_pk_bf16_f32 v15, v51, v51
    v_and_b32 v14, v15, v4
    v_and_b32 v15, v15, v5
    s_waitcnt vmcnt(63)
    v_mfma_f32_16x16x16_bf16 v[32:35], v[12:13], v[124:125], v[32:35]
    v_mfma_f32_16x16x16_bf16 v[36:39], v[12:13], v[126:127], v[36:39]
    buffer_load_dwordx4 v[124:127], v3, s[12:15], s49 offen offset:256 nt
    v_cvt_pk_bf16_f32 v9, v52, v52
    v_and_b32 v8, v9, v4
    v_and_b32 v9, v9, v5
    s_waitcnt vmcnt(63)
    v_mfma_f32_16x16x16_bf16 v[32:35], v[14:15], v[128:129], v[32:35]
    v_mfma_f32_16x16x16_bf16 v[36:39], v[14:15], v[130:131], v[36:39]
    buffer_load_dwordx4 v[128:131], v3, s[12:15], s49 offen offset:512 nt
    v_cvt_pk_bf16_f32 v11, v53, v53
    v_and_b32 v10, v11, v4
    v_and_b32 v11, v11, v5
    s_waitcnt vmcnt(63)
    v_mfma_f32_16x16x16_bf16 v[32:35], v[8:9], v[132:133], v[32:35]
    v_mfma_f32_16x16x16_bf16 v[36:39], v[8:9], v[134:135], v[36:39]
    buffer_load_dwordx4 v[132:135], v3, s[12:15], s49 offen offset:768 nt
    v_cvt_pk_bf16_f32 v13, v54, v54
    v_and_b32 v12, v13, v4
    v_and_b32 v13, v13, v5
    s_waitcnt vmcnt(63)
    v_mfma_f32_16x16x16_bf16 v[32:35], v[10:11], v[136:137], v[32:35]
    v_mfma_f32_16x16x16_bf16 v[36:39], v[10:11], v[138:139], v[36:39]
    s_mov_b32 s49, 45056
    buffer_load_dwordx4 v[136:139], v3, s[12:15], s49 offen offset:0 nt
    v_cvt_pk_bf16_f32 v15, v55, v55
    v_and_b32 v14, v15, v4
    v_and_b32 v15, v15, v5
    s_waitcnt vmcnt(63)
    v_mfma_f32_16x16x16_bf16 v[32:35], v[12:13], v[140:141], v[32:35]
    v_mfma_f32_16x16x16_bf16 v[36:39], v[12:13], v[142:143], v[36:39]
    buffer_load_dwordx4 v[140:143], v3, s[12:15], s49 offen offset:256 nt
    v_cvt_pk_bf16_f32 v9, v56, v56
    v_and_b32 v8, v9, v4
    v_and_b32 v9, v9, v5
    s_waitcnt vmcnt(63)
    v_mfma_f32_16x16x16_bf16 v[32:35], v[14:15], v[144:145], v[32:35]
    v_mfma_f32_16x16x16_bf16 v[36:39], v[14:15], v[146:147], v[36:39]
    buffer_load_dwordx4 v[144:147], v3, s[12:15], s49 offen offset:512 nt
    v_cvt_pk_bf16_f32 v11, v57, v57
    v_and_b32 v10, v11, v4
    v_and_b32 v11, v11, v5
    s_waitcnt vmcnt(63)
    v_mfma_f32_16x16x16_bf16 v[32:35], v[8:9], v[148:149], v[32:35]
    v_mfma_f32_16x16x16_bf16 v[36:39], v[8:9], v[150:151], v[36:39]
    buffer_load_dwordx4 v[148:151], v3, s[12:15], s49 offen offset:768 nt
    v_cvt_pk_bf16_f32 v13, v58, v58
    v_and_b32 v12, v13, v4
    v_and_b32 v13, v13, v5
    s_waitcnt vmcnt(63)
    v_mfma_f32_16x16x16_bf16 v[32:35], v[10:11], v[152:153], v[32:35]
    v_mfma_f32_16x16x16_bf16 v[36:39], v[10:11], v[154:155], v[36:39]
    s_mov_b32 s49, 49152
    buffer_load_dwordx4 v[152:155], v3, s[12:15], s49 offen offset:0 nt
    v_cvt_pk_bf16_f32 v15, v59, v59
    v_and_b32 v14, v15, v4
    v_and_b32 v15, v15, v5
    s_waitcnt vmcnt(63)
    v_mfma_f32_16x16x16_bf16 v[32:35], v[12:13], v[156:157], v[32:35]
    v_mfma_f32_16x16x16_bf16 v[36:39], v[12:13], v[158:159], v[36:39]
    buffer_load_dwordx4 v[156:159], v3, s[12:15], s49 offen offset:256 nt
    v_cvt_pk_bf16_f32 v9, v60, v60
    v_and_b32 v8, v9, v4
    v_and_b32 v9, v9, v5
    s_waitcnt vmcnt(63)
    v_mfma_f32_16x16x16_bf16 v[32:35], v[14:15], v[160:161], v[32:35]
    v_mfma_f32_16x16x16_bf16 v[36:39], v[14:15], v[162:163], v[36:39]
    buffer_load_dwordx4 v[160:163], v3, s[12:15], s49 offen offset:512 nt
    v_cvt_pk_bf16_f32 v11, v61, v61
    v_and_b32 v10, v11, v4
    v_and_b32 v11, v11, v5
    s_waitcnt vmcnt(63)
    v_mfma_f32_16x16x16_bf16 v[32:35], v[8:9], v[164:165], v[32:35]
    v_mfma_f32_16x16x16_bf16 v[36:39], v[8:9], v[166:167], v[36:39]
    buffer_load_dwordx4 v[164:167], v3, s[12:15], s49 offen offset:768 nt
    v_cvt_pk_bf16_f32 v13, v62, v62
    v_and_b32 v12, v13, v4
    v_and_b32 v13, v13, v5
    s_waitcnt vmcnt(63)
    v_mfma_f32_16x16x16_bf16 v[32:35], v[10:11], v[168:169], v[32:35]
    v_mfma_f32_16x16x16_bf16 v[36:39], v[10:11], v[170:171], v[36:39]
    s_mov_b32 s49, 53248
    buffer_load_dwordx4 v[168:171], v3, s[12:15], s49 offen offset:0 nt
    v_cvt_pk_bf16_f32 v15, v63, v63
    v_and_b32 v14, v15, v4
    v_and_b32 v15, v15, v5
    s_waitcnt vmcnt(63)
    v_mfma_f32_16x16x16_bf16 v[32:35], v[12:13], v[172:173], v[32:35]
    v_mfma_f32_16x16x16_bf16 v[36:39], v[12:13], v[174:175], v[36:39]
    buffer_load_dwordx4 v[172:175], v3, s[12:15], s49 offen offset:256 nt
    v_cvt_pk_bf16_f32 v9, v64, v64
    v_and_b32 v8, v9, v4
    v_and_b32 v9, v9, v5
    s_waitcnt vmcnt(63)
    v_mfma_f32_16x16x16_bf16 v[32:35], v[14:15], v[176:177], v[32:35]
    v_mfma_f32_16x16x16_bf16 v[36:39], v[14:15], v[178:179], v[36:39]
    buffer_load_dwordx4 v[176:179], v3, s[12:15], s49 offen offset:512 nt
    v_cvt_pk_bf16_f32 v11, v65, v65
    v_and_b32 v10, v11, v4
    v_and_b32 v11, v11, v5
    s_waitcnt vmcnt(63)
    v_mfma_f32_16x16x16_bf16 v[32:35], v[8:9], v[180:181], v[32:35]
    v_mfma_f32_16x16x16_bf16 v[36:39], v[8:9], v[182:183], v[36:39]
    buffer_load_dwordx4 v[180:183], v3, s[12:15], s49 offen offset:768 nt
    v_cvt_pk_bf16_f32 v13, v66, v66
    v_and_b32 v12, v13, v4
    v_and_b32 v13, v13, v5
    s_waitcnt vmcnt(63)
    v_mfma_f32_16x16x16_bf16 v[32:35], v[10:11], v[184:185], v[32:35]
    v_mfma_f32_16x16x16_bf16 v[36:39], v[10:11], v[186:187], v[36:39]
    v_cvt_pk_bf16_f32 v15, v67, v67
    v_and_b32 v14, v15, v4
    v_and_b32 v15, v15, v5
    s_waitcnt vmcnt(62)
    v_mfma_f32_16x16x16_bf16 v[32:35], v[12:13], v[188:189], v[32:35]
    v_mfma_f32_16x16x16_bf16 v[36:39], v[12:13], v[190:191], v[36:39]
    v_cvt_pk_bf16_f32 v9, v68, v68
    v_and_b32 v8, v9, v4
    v_and_b32 v9, v9, v5
    s_waitcnt vmcnt(61)
    v_mfma_f32_16x16x16_bf16 v[32:35], v[14:15], v[192:193], v[32:35]
    v_mfma_f32_16x16x16_bf16 v[36:39], v[14:15], v[194:195], v[36:39]
    v_cvt_pk_bf16_f32 v11, v69, v69
    v_and_b32 v10, v11, v4
    v_and_b32 v11, v11, v5
    s_waitcnt vmcnt(60)
    v_mfma_f32_16x16x16_bf16 v[32:35], v[8:9], v[196:197], v[32:35]
    v_mfma_f32_16x16x16_bf16 v[36:39], v[8:9], v[198:199], v[36:39]
    v_cvt_pk_bf16_f32 v13, v70, v70
    v_and_b32 v12, v13, v4
    v_and_b32 v13, v13, v5
    s_waitcnt vmcnt(59)
    v_mfma_f32_16x16x16_bf16 v[32:35], v[10:11], v[200:201], v[32:35]
    v_mfma_f32_16x16x16_bf16 v[36:39], v[10:11], v[202:203], v[36:39]
    v_cvt_pk_bf16_f32 v15, v71, v71
    v_and_b32 v14, v15, v4
    v_and_b32 v15, v15, v5
    s_waitcnt vmcnt(58)
    v_mfma_f32_16x16x16_bf16 v[32:35], v[12:13], v[204:205], v[32:35]
    v_mfma_f32_16x16x16_bf16 v[36:39], v[12:13], v[206:207], v[36:39]
    v_cvt_pk_bf16_f32 v9, v72, v72
    v_and_b32 v8, v9, v4
    v_and_b32 v9, v9, v5
    s_waitcnt vmcnt(24)
    v_mfma_f32_16x16x16_bf16 v[32:35], v[14:15], v[208:209], v[32:35]
    v_mfma_f32_16x16x16_bf16 v[36:39], v[14:15], v[210:211], v[36:39]
    v_cvt_pk_bf16_f32 v11, v73, v73
    v_and_b32 v10, v11, v4
    v_and_b32 v11, v11, v5
    s_waitcnt vmcnt(23)
    v_mfma_f32_16x16x16_bf16 v[32:35], v[8:9], v[212:213], v[32:35]
    v_mfma_f32_16x16x16_bf16 v[36:39], v[8:9], v[214:215], v[36:39]
    v_cvt_pk_bf16_f32 v13, v74, v74
    v_and_b32 v12, v13, v4
    v_and_b32 v13, v13, v5
    s_waitcnt vmcnt(22)
    v_mfma_f32_16x16x16_bf16 v[32:35], v[10:11], v[216:217], v[32:35]
    v_mfma_f32_16x16x16_bf16 v[36:39], v[10:11], v[218:219], v[36:39]
    v_lshl_or_b32 v232, v16, 16, v232
    v_lshl_or_b32 v233, v17, 16, v233
    v_lshl_or_b32 v234, v18, 16, v234
    v_lshl_or_b32 v235, v19, 16, v235
    v_lshl_or_b32 v236, v20, 16, v236
    v_lshl_or_b32 v237, v21, 16, v237
    v_lshl_or_b32 v238, v22, 16, v238
    v_lshl_or_b32 v239, v23, 16, v239
    v_lshl_or_b32 v240, v24, 16, v240
    v_lshl_or_b32 v241, v25, 16, v241
    v_lshl_or_b32 v242, v26, 16, v242
    v_lshl_or_b32 v243, v27, 16, v243
    v_lshl_or_b32 v244, v28, 16, v244
    v_lshl_or_b32 v245, v29, 16, v245
    v_lshl_or_b32 v246, v30, 16, v246
    v_lshl_or_b32 v247, v31, 16, v247
    v_cvt_pk_bf16_f32 v15, v75, v75
    v_and_b32 v14, v15, v4
    v_and_b32 v15, v15, v5
    s_waitcnt vmcnt(21)
    v_mfma_f32_16x16x16_bf16 v[32:35], v[12:13], v[220:221], v[32:35]
    v_mfma_f32_16x16x16_bf16 v[36:39], v[12:13], v[222:223], v[36:39]
    v_cvt_pk_bf16_f32 v9, v76, v76
    v_and_b32 v8, v9, v4
    v_and_b32 v9, v9, v5
    s_waitcnt vmcnt(20)
    v_mfma_f32_16x16x16_bf16 v[32:35], v[14:15], v[224:225], v[32:35]
    v_mfma_f32_16x16x16_bf16 v[36:39], v[14:15], v[226:227], v[36:39]
    v_cvt_pk_bf16_f32 v11, v77, v77
    v_and_b32 v10, v11, v4
    v_and_b32 v11, v11, v5
    s_waitcnt vmcnt(19)
    v_mfma_f32_16x16x16_bf16 v[32:35], v[8:9], v[228:229], v[32:35]
    v_mfma_f32_16x16x16_bf16 v[36:39], v[8:9], v[230:231], v[36:39]
    v_cvt_pk_bf16_f32 v13, v78, v78
    v_and_b32 v12, v13, v4
    v_and_b32 v13, v13, v5
    s_waitcnt vmcnt(18)
    v_mfma_f32_16x16x16_bf16 v[32:35], v[10:11], v[108:109], v[32:35]
    v_mfma_f32_16x16x16_bf16 v[36:39], v[10:11], v[110:111], v[36:39]
    v_cvt_pk_bf16_f32 v15, v79, v79
    v_and_b32 v14, v15, v4
    v_and_b32 v15, v15, v5
    s_waitcnt vmcnt(17)
    v_mfma_f32_16x16x16_bf16 v[32:35], v[12:13], v[112:113], v[32:35]
    v_mfma_f32_16x16x16_bf16 v[36:39], v[12:13], v[114:115], v[36:39]
    v_cvt_pk_bf16_f32 v9, v80, v80
    v_and_b32 v8, v9, v4
    v_and_b32 v9, v9, v5
    s_waitcnt vmcnt(16)
    v_mfma_f32_16x16x16_bf16 v[32:35], v[14:15], v[116:117], v[32:35]
    v_mfma_f32_16x16x16_bf16 v[36:39], v[14:15], v[118:119], v[36:39]
    v_cvt_pk_bf16_f32 v11, v81, v81
    v_and_b32 v10, v11, v4
    v_and_b32 v11, v11, v5
    s_waitcnt vmcnt(15)
    v_mfma_f32_16x16x16_bf16 v[32:35], v[8:9], v[120:121], v[32:35]
    v_mfma_f32_16x16x16_bf16 v[36:39], v[8:9], v[122:123], v[36:39]
    s_cmp_lg_u32 s3, 0
    s_cbranch_scc1 L_NOFLP
    buffer_load_dword v253, v248, s[40:43], 0 offen sc0 sc1
L_NOFLP:
    v_cvt_pk_bf16_f32 v13, v82, v82
    v_and_b32 v12, v13, v4
    v_and_b32 v13, v13, v5
    s_waitcnt vmcnt(14)
    v_mfma_f32_16x16x16_bf16 v[32:35], v[10:11], v[124:125], v[32:35]
    v_mfma_f32_16x16x16_bf16 v[36:39], v[10:11], v[126:127], v[36:39]
    v_cvt_pk_bf16_f32 v15, v83, v83
    v_and_b32 v14, v15, v4
    v_and_b32 v15, v15, v5
    s_waitcnt vmcnt(13)
    v_mfma_f32_16x16x16_bf16 v[32:35], v[12:13], v[128:129], v[32:35]
    v_mfma_f32_16x16x16_bf16 v[36:39], v[12:13], v[130:131], v[36:39]
    v_cvt_pk_bf16_f32 v9, v84, v84
    v_and_b32 v8, v9, v4
    v_and_b32 v9, v9, v5
    s_waitcnt vmcnt(12)
    v_mfma_f32_16x16x16_bf16 v[32:35], v[14:15], v[132:133], v[32:35]
    v_mfma_f32_16x16x16_bf16 v[36:39], v[14:15], v[134:135], v[36:39]
    v_cvt_pk_bf16_f32 v11, v85, v85
    v_and_b32 v10, v11, v4
    v_and_b32 v11, v11, v5
    s_waitcnt vmcnt(11)
    v_mfma_f32_16x16x16_bf16 v[32:35], v[8:9], v[136:137], v[32:35]
    v_mfma_f32_16x16x16_bf16 v[36:39], v[8:9], v[138:139], v[36:39]
    v_cvt_pk_bf16_f32 v13, v86, v86
    v_and_b32 v12, v13, v4
    v_and_b32 v13, v13, v5
    s_waitcnt vmcnt(10)
    v_mfma_f32_16x16x16_bf16 v[32:35], v[10:11], v[140:141], v[32:35]
    v_mfma_f32_16x16x16_bf16 v[36:39], v[10:11], v[142:143], v[36:39]
    v_cvt_pk_bf16_f32 v15, v87, v87
    v_and_b32 v14, v15, v4
    v_and_b32 v15, v15, v5
    s_waitcnt vmcnt(9)
    v_mfma_f32_16x16x16_bf16 v[32:35], v[12:13], v[144:145], v[32:35]
    v_mfma_f32_16x16x16_bf16 v[36:39], v[12:13], v[146:147], v[36:39]
    v_cvt_pk_bf16_f32 v9, v88, v88
    v_and_b32 v8, v9, v4
    v_and_b32 v9, v9, v5
    s_waitcnt vmcnt(8)
    v_mfma_f32_16x16x16_bf16 v[32:35], v[14:15], v[148:149], v[32:35]
    v_mfma_f32_16x16x16_bf16 v[36:39], v[14:15], v[150:151], v[36:39]
    v_cvt_pk_bf16_f32 v11, v89, v89
    v_and_b32 v10, v11, v4
    v_and_b32 v11, v11, v5
    s_waitcnt vmcnt(7)
    v_mfma_f32_16x16x16_bf16 v[32:35], v[8:9], v[152:153], v[32:35]
    v_mfma_f32_16x16x16_bf16 v[36:39], v[8:9], v[154:155], v[36:39]
    v_cvt_pk_bf16_f32 v13, v90, v90
    v_and_b32 v12, v13, v4
    v_and_b32 v13, v13, v5
    s_waitcnt vmcnt(6)
    v_mfma_f32_16x16x16_bf16 v[32:35], v[10:11], v[156:157], v[32:35]
    v_mfma_f32_16x16x16_bf16 v[36:39], v[10:11], v[158:159], v[36:39]
    v_cvt_pk_bf16_f32 v15, v91, v91
    v_and_b32 v14, v15, v4
    v_and_b32 v15, v15, v5
    s_waitcnt vmcnt(5)
    v_mfma_f32_16x16x16_bf16 v[32:35], v[12:13], v[160:161], v[32:35]
    v_mfma_f32_16x16x16_bf16 v[36:39], v[12:13], v[162:163], v[36:39]
    v_cvt_pk_bf16_f32 v9, v92, v92
    v_and_b32 v8, v9, v4
    v_and_b32 v9, v9, v5
    s_waitcnt vmcnt(4)
    v_mfma_f32_16x16x16_bf16 v[32:35], v[14:15], v[164:165], v[32:35]
    v_mfma_f32_16x16x16_bf16 v[36:39], v[14:15], v[166:167], v[36:39]
    v_cvt_pk_bf16_f32 v11, v93, v93
    v_and_b32 v10, v11, v4
    v_and_b32 v11, v11, v5
    s_waitcnt vmcnt(3)
    v_mfma_f32_16x16x16_bf16 v[32:35], v[8:9], v[168:169], v[32:35]
    v_mfma_f32_16x16x16_bf16 v[36:39], v[8:9], v[170:171], v[36:39]
    v_cvt_pk_bf16_f32 v13, v94, v94
    v_and_b32 v12, v13, v4
    v_and_b32 v13, v13, v5
    s_waitcnt vmcnt(2)
    v_mfma_f32_16x16x16_bf16 v[32:35], v[10:11], v[172:173], v[32:35]
    v_mfma_f32_16x16x16_bf16 v[36:39], v[10:11], v[174:175], v[36:39]
    v_cvt_pk_bf16_f32 v15, v95, v95
    v_and_b32 v14, v15, v4
    v_and_b32 v15, v15, v5
    s_waitcnt vmcnt(1)
    v_mfma_f32_16x16x16_bf16 v[32:35], v[12:13], v[176:177], v[32:35]
    v_mfma_f32_16x16x16_bf16 v[36:39], v[12:13], v[178:179], v[36:39]
    s_nop 1
    s_waitcnt vmcnt(0)
    v_mfma_f32_16x16x16_bf16 v[32:35], v[14:15], v[180:181], v[32:35]
    v_mfma_f32_16x16x16_bf16 v[36:39], v[14:15], v[182:183], v[36:39]
    s_branch L_TAIL
L_MAINB:
    s_waitcnt vmcnt(27)
    v_mfma_f32_16x16x32_bf16 v[40:43], v[108:111], v[16:19], 0
    v_mfma_f32_16x16x32_bf16 v[24:27], v[116:119], v[16:19], 0
    v_mfma_f32_16x16x32_bf16 v[40:43], v[112:115], v[20:23], v[40:43]
    v_mfma_f32_16x16x32_bf16 v[24:27], v[120:123], v[20:23], v[24:27]
    buffer_load_dwordx4 v[108:111], v2, s[8:11], s48 offen offset:2176 nt
    s_mov_b32 s48, 32768
    buffer_load_dwordx4 v[112:115], v2, s[8:11], s48 offen offset:0 nt
    buffer_load_dwordx4 v[116:119], v2, s[8:11], s48 offen offset:128 nt
    buffer_load_dwordx4 v[120:123], v2, s[8:11], s48 offen offset:2048 nt
    s_waitcnt vmcnt(27)
    v_mfma_f32_16x16x32_bf16 v[44:47], v[124:127], v[16:19], 0
    v_mfma_f32_16x16x32_bf16 v[28:31], v[132:135], v[16:19], 0
    v_mfma_f32_16x16x32_bf16 v[44:47], v[128:131], v[20:23], v[44:47]
    v_mfma_f32_16x16x32_bf16 v[28:31], v[136:139], v[20:23], v[28:31]
    buffer_load_dwordx4 v[124:127], v2, s[8:11], s48 offen offset:2176 nt
    s_mov_b32 s48, 36864
    buffer_load_dwordx4 v[128:131], v2, s[8:11], s48 offen offset:0 nt
    buffer_load_dwordx4 v[132:135], v2, s[8:11], s48 offen offset:128 nt
    buffer_load_dwordx4 v[136:139], v2, s[8:11], s48 offen offset:2048 nt
    s_nop 3
    v_permlane32_swap_b32 v40, v24
    v_permlane32_swap_b32 v41, v25
    v_permlane32_swap_b32 v42, v26
    v_permlane32_swap_b32 v43, v27
    s_nop 1
    v_mov_b32 v8, v40 quad_perm:[0,0,2,2] row_mask:0xf bank_mask:0xf
    v_mov_b32 v9, v41 quad_perm:[0,0,2,2] row_mask:0xf bank_mask:0xf
    v_mov_b32 v10, v42 quad_perm:[0,0,2,2] row_mask:0xf bank_mask:0xf
    v_mov_b32 v11, v43 quad_perm:[0,0,2,2] row_mask:0xf bank_mask:0xf
    v_add_f32 v40, v24, v8 quad_perm:[1,1,3,3] row_mask:0xf bank_mask:0xf
    v_add_f32 v41, v25, v9 quad_perm:[1,1,3,3] row_mask:0xf bank_mask:0xf
    v_add_f32 v42, v26, v10 quad_perm:[1,1,3,3] row_mask:0xf bank_mask:0xf
    v_add_f32 v43, v27, v11 quad_perm:[1,1,3,3] row_mask:0xf bank_mask:0xf
    s_waitcnt vmcnt(27)
    v_mfma_f32_16x16x32_bf16 v[48:51], v[140:143], v[16:19], 0
    v_mfma_f32_16x16x32_bf16 v[24:27], v[148:151], v[16:19], 0
    v_mfma_f32_16x16x32_bf16 v[48:51], v[144:147], v[20:23], v[48:51]
    v_mfma_f32_16x16x32_bf16 v[24:27], v[152:155], v[20:23], v[24:27]
    buffer_load_dwordx4 v[140:143], v2, s[8:11], s48 offen offset:2176 nt
    s_mov_b32 s49, 0
    buffer_load_dwordx4 v[144:147], v3, s[12:15], s49 offen offset:0 nt
    buffer_load_dwordx4 v[148:151], v3, s[12:15], s49 offen offset:256 nt
    buffer_load_dwordx4 v[152:155], v3, s[12:15], s49 offen offset:512 nt
    s_nop 3
    v_permlane32_swap_b32 v44, v28
    v_permlane32_swap_b32 v45, v29
    v_permlane32_swap_b32 v46, v30
    v_permlane32_swap_b32 v47, v31
    s_nop 1
    v_mov_b32 v8, v44 quad_perm:[0,0,2,2] row_mask:0xf bank_mask:0xf
    v_mov_b32 v9, v45 quad_perm:[0,0,2,2] row_mask:0xf bank_mask:0xf
    v_mov_b32 v10, v46 quad_perm:[0,0,2,2] row_mask:0xf bank_mask:0xf
    v_mov_b32 v11, v47 quad_perm:[0,0,2,2] row_mask:0xf bank_mask:0xf
    v_add_f32 v44, v28, v8 quad_perm:[1,1,3,3] row_mask:0xf bank_mask:0xf
    v_add_f32 v45, v29, v9 quad_perm:[1,1,3,3] row_mask:0xf bank_mask:0xf
    v_add_f32 v46, v30, v10 quad_perm:[1,1,3,3] row_mask:0xf bank_mask:0xf
    v_add_f32 v47, v31, v11 quad_perm:[1,1,3,3] row_mask:0xf bank_mask:0xf
    s_waitcnt vmcnt(27)
    v_mfma_f32_16x16x32_bf16 v[52:55], v[156:159], v[16:19], 0
    v_mfma_f32_16x16x32_bf16 v[28:31], v[164:167], v[16:19], 0
    v_mfma_f32_16x16x32_bf16 v[52:55], v[160:163], v[20:23], v[52:55]
    v_mfma_f32_16x16x32_bf16 v[28:31], v[168:171], v[20:23], v[28:31]
    buffer_load_dwordx4 v[156:159], v3, s[12:15], s49 offen offset:768 nt
    s_mov_b32 s49, 4096
    buffer_load_dwordx4 v[160:163], v3, s[12:15], s49 offen offset:0 nt
    buffer_load_dwordx4 v[164:167], v3, s[12:15], s49 offen offset:256 nt
    buffer_load_dwordx4 v[168:171], v3, s[12:15], s49 offen offset:512 nt
    s_nop 3
    v_permlane32_swap_b32 v48, v24
    v_permlane32_swap_b32 v49, v25
    v_permlane32_swap_b32 v50, v26
    v_permlane32_swap_b32 v51, v27
    s_nop 1
    v_mov_b32 v8, v48 quad_perm:[0,0,2,2] row_mask:0xf bank_mask:0xf
    v_mov_b32 v9, v49 quad_perm:[0,0,2,2] row_mask:0xf bank_mask:0xf
    v_mov_b32 v10, v50 quad_perm:[0,0,2,2] row_mask:0xf bank_mask:0xf
    v_mov_b32 v11, v51 quad_perm:[0,0,2,2] row_mask:0xf bank_mask:0xf
    v_add_f32 v48, v24, v8 quad_perm:[1,1,3,3] row_mask:0xf bank_mask:0xf
    v_add_f32 v49, v25, v9 quad_perm:[1,1,3,3] row_mask:0xf bank_mask:0xf
    v_add_f32 v50, v26, v10 quad_perm:[1,1,3,3] row_mask:0xf bank_mask:0xf
    v_add_f32 v51, v27, v11 quad_perm:[1,1,3,3] row_mask:0xf bank_mask:0xf
    s_waitcnt vmcnt(27)
    v_mfma_f32_16x16x32_bf16 v[56:59], v[172:175], v[16:19], 0
    v_mfma_f32_16x16x32_bf16 v[24:27], v[180:183], v[16:19], 0
    v_mfma_f32_16x16x32_bf16 v[56:59], v[176:179], v[20:23], v[56:59]
    v_mfma_f32_16x16x32_bf16 v[24:27], v[184:187], v[20:23], v[24:27]
    buffer_load_dwordx4 v[172:175], v3, s[12:15], s49 offen offset:768 nt
    s_mov_b32 s49, 8192
    buffer_load_dwordx4 v[176:179], v3, s[12:15], s49 offen offset:0 nt
    buffer_load_dwordx4 v[180:183], v3, s[12:15], s49 offen offset:256 nt
    buffer_load_dwordx4 v[184:187], v3, s[12:15], s49 offen offset:512 nt
    s_nop 3
    v_permlane32_swap_b32 v52, v28
    v_permlane32_swap_b32 v53, v29
    v_permlane32_swap_b32 v54, v30
    v_permlane32_swap_b32 v55, v31
    s_nop 1
    v_mov_b32 v8, v52 quad_perm:[0,0,2,2] row_mask:0xf bank_mask:0xf
    v_mov_b32 v9, v53 quad_perm:[0,0,2,2] row_mask:0xf bank_mask:0xf
    v_mov_b32 v10, v54 quad_perm:[0,0,2,2] row_mask:0xf bank_mask:0xf
    v_mov_b32 v11, v55 quad_perm:[0,0,2,2] row_mask:0xf bank_mask:0xf
    v_add_f32 v52, v28, v8 quad_perm:[1,1,3,3] row_mask:0xf bank_mask:0xf
    v_add_f32 v53, v29, v9 quad_perm:[1,1,3,3] row_mask:0xf bank_mask:0xf
    v_add_f32 v54, v30, v10 quad_perm:[1,1,3,3] row_mask:0xf bank_mask:0xf
    v_add_f32 v55, v31, v11 quad_perm:[1,1,3,3] row_mask:0xf bank_mask:0xf
    s_waitcnt vmcnt(27)
    v_mfma_f32_16x16x32_bf16 v[60:63], v[188:191], v[16:19], 0
    v_mfma_f32_16x16x32_bf16 v[28:31], v[196:199], v[16:19], 0
    v_mfma_f32_16x16x32_bf16 v[60:63], v[192:195], v[20:23], v[60:63]
    v_mfma_f32_16x16x32_bf16 v[28:31], v[200:203], v[20:23], v[28:31]
    buffer_load_dwordx4 v[188:191], v3, s[12:15], s49 offen offset:768 nt
    s_mov_b32 s49, 12288
    buffer_load_dwordx4 v[192:195], v3, s[12:15], s49 offen offset:0 nt
    buffer_load_dwordx4 v[196:199], v3, s[12:15], s49 offen offset:256 nt
    buffer_load_dwordx4 v[200:203], v3, s[12:15], s49 offen offset:512 nt
    s_nop 3
    v_permlane32_swap_b32 v56, v24
    v_permlane32_swap_b32 v57, v25
    v_permlane32_swap_b32 v58, v26
    v_permlane32_swap_b32 v59, v27
    s_nop 1
    v_mov_b32 v8, v56 quad_perm:[0,0,2,2] row_mask:0xf bank_mask:0xf
    v_mov_b32 v9, v57 quad_perm:[0,0,2,2] row_mask:0xf bank_mask:0xf
    v_mov_b32 v10, v58 quad_perm:[0,0,2,2] row_mask:0xf bank_mask:0xf
    v_mov_b32 v11, v59 quad_perm:[0,0,2,2] row_mask:0xf bank_mask:0xf
    v_add_f32 v56, v24, v8 quad_perm:[1,1,3,3] row_mask:0xf bank_mask:0xf
    v_add_f32 v57, v25, v9 quad_perm:[1,1,3,3] row_mask:0xf bank_mask:0xf
    v_add_f32 v58, v26, v10 quad_perm:[1,1,3,3] row_mask:0xf bank_mask:0xf
    v_add_f32 v59, v27, v11 quad_perm:[1,1,3,3] row_mask:0xf bank_mask:0xf
    s_waitcnt vmcnt(27)
    v_mfma_f32_16x16x32_bf16 v[64:67], v[204:207], v[16:19], 0
    v_mfma_f32_16x16x32_bf16 v[24:27], v[212:215], v[16:19], 0
    v_mfma_f32_16x16x32_bf16 v[64:67], v[208:211], v[20:23], v[64:67]
    v_mfma_f32_16x16x32_bf16 v[24:27], v[216:219], v[20:23], v[24:27]
    buffer_load_dwordx4 v[204:207], v3, s[12:15], s49 offen offset:768 nt
    s_mov_b32 s49, 16384
    buffer_load_dwordx4 v[208:211], v3, s[12:15], s49 offen offset:0 nt
    buffer_load_dwordx4 v[212:215], v3, s[12:15], s49 offen offset:256 nt
    buffer_load_dwordx4 v[216:219], v3, s[12:15], s49 offen offset:512 nt
    s_nop 3
    v_permlane32_swap_b32 v60, v28
    v_permlane32_swap_b32 v61, v29
    v_permlane32_swap_b32 v62, v30
    v_permlane32_swap_b32 v63, v31
    s_nop 1
    v_mov_b32 v8, v60 quad_perm:[0,0,2,2] row_mask:0xf bank_mask:0xf
    v_mov_b32 v9, v61 quad_perm:[0,0,2,2] row_mask:0xf bank_mask:0xf
    v_mov_b32 v10, v62 quad_perm:[0,0,2,2] row_mask:0xf bank_mask:0xf
    v_mov_b32 v11, v63 quad_perm:[0,0,2,2] row_mask:0xf bank_mask:0xf
    v_add_f32 v60, v28, v8 quad_perm:[1,1,3,3] row_mask:0xf bank_mask:0xf
    v_add_f32 v61, v29, v9 quad_perm:[1,1,3,3] row_mask:0xf bank_mask:0xf
    v_add_f32 v62, v30, v10 quad_perm:[1,1,3,3] row_mask:0xf bank_mask:0xf
    v_add_f32 v63, v31, v11 quad_perm:[1,1,3,3] row_mask:0xf bank_mask:0xf
    s_waitcnt vmcnt(27)
    v_mfma_f32_16x16x32_bf16 v[68:71], v[220:223], v[16:19], 0
    v_mfma_f32_16x16x32_bf16 v[28:31], v[228:231], v[16:19], 0
    v_mfma_f32_16x16x32_bf16 v[68:71], v[224:227], v[20:23], v[68:71]
    v_mfma_f32_16x16x32_bf16 v[28:31], v[108:111], v[20:23], v[28:31]
    buffer_load_dwordx4 v[220:223], v3, s[12:15], s49 offen offset:768 nt
    s_mov_b32 s49, 20480
    buffer_load_dwordx4 v[224:227], v3, s[12:15], s49 offen offset:0 nt
    buffer_load_dwordx4 v[228:231], v3, s[12:15], s49 offen offset:256 nt
    buffer_load_dwordx4 v[108:111], v3, s[12:15], s49 offen offset:512 nt
    s_nop 3
    v_permlane32_swap_b32 v64, v24
    v_permlane32_swap_b32 v65, v25
    v_permlane32_swap_b32 v66, v26
    v_permlane32_swap_b32 v67, v27
    s_nop 1
    v_mov_b32 v8, v64 quad_perm:[0,0,2,2] row_mask:0xf bank_mask:0xf
    v_mov_b32 v9, v65 quad_perm:[0,0,2,2] row_mask:0xf bank_mask:0xf
    v_mov_b32 v10, v66 quad_perm:[0,0,2,2] row_mask:0xf bank_mask:0xf
    v_mov_b32 v11, v67 quad_perm:[0,0,2,2] row_mask:0xf bank_mask:0xf
    v_add_f32 v64, v24, v8 quad_perm:[1,1,3,3] row_mask:0xf bank_mask:0xf
    v_add_f32 v65, v25, v9 quad_perm:[1,1,3,3] row_mask:0xf bank_mask:0xf
    v_add_f32 v66, v26, v10 quad_perm:[1,1,3,3] row_mask:0xf bank_mask:0xf
    v_add_f32 v67, v27, v11 quad_perm:[1,1,3,3] row_mask:0xf bank_mask:0xf
    s_waitcnt vmcnt(27)
    v_mfma_f32_16x16x32_bf16 v[72:75], v[112:115], v[16:19], 0
    v_mfma_f32_16x16x32_bf16 v[24:27], v[120:123], v[16:19], 0
    v_mfma_f32_16x16x32_bf16 v[72:75], v[116:119], v[20:23], v[72:75]
    v_mfma_f32_16x16x32_bf16 v[24:27], v[124:127], v[20:23], v[24:27]
    buffer_load_dwordx4 v[112:115], v3, s[12:15], s49 offen offset:768 nt
    s_mov_b32 s49, 24576
    buffer_load_dwordx4 v[116:119], v3, s[12:15], s49 offen offset:0 nt
    buffer_load_dwordx4 v[120:123], v3, s[12:15], s49 offen offset:256 nt
    buffer_load_dwordx4 v[124:127], v3, s[12:15], s49 offen offset:512 nt
    s_nop 3
    v_permlane32_swap_b32 v68, v28
    v_permlane32_swap_b32 v69, v29
    v_permlane32_swap_b32 v70, v30
    v_permlane32_swap_b32 v71, v31
    s_nop 1
    v_mov_b32 v8, v68 quad_perm:[0,0,2,2] row_mask:0xf bank_mask:0xf
    v_mov_b32 v9, v69 quad_perm:[0,0,2,2] row_mask:0xf bank_mask:0xf
    v_mov_b32 v10, v70 quad_perm:[0,0,2,2] row_mask:0xf bank_mask:0xf
    v_mov_b32 v11, v71 quad_perm:[0,0,2,2] row_mask:0xf bank_mask:0xf
    v_add_f32 v68, v28, v8 quad_perm:[1,1,3,3] row_mask:0xf bank_mask:0xf
    v_add_f32 v69, v29, v9 quad_perm:[1,1,3,3] row_mask:0xf bank_mask:0xf
    v_add_f32 v70, v30, v10 quad_perm:[1,1,3,3] row_mask:0xf bank_mask:0xf
    v_add_f32 v71, v31, v11 quad_perm:[1,1,3,3] row_mask:0xf bank_mask:0xf
    s_waitcnt vmcnt(27)
    v_mfma_f32_16x16x32_bf16 v[76:79], v[128:131], v[16:19], 0
    v_mfma_f32_16x16x32_bf16 v[28:31], v[136:139], v[16:19], 0
    v_mfma_f32_16x16x32_bf16 v[76:79], v[132:135], v[20:23], v[76:79]
    v_mfma_f32_16x16x32_bf16 v[28:31], v[140:143], v[20:23], v[28:31]
    buffer_load_dwordx4 v[128:131], v3, s[12:15], s49 offen offset:768 nt
    s_mov_b32 s49, 28672
    buffer_load_dwordx4 v[132:135], v3, s[12:15], s49 offen offset:0 nt
    buffer_load_dwordx4 v[136:139], v3, s[12:15], s49 offen offset:256 nt
    buffer_load_dwordx4 v[140:143], v3, s[12:15], s49 offen offset:512 nt
    s_nop 3
    v_permlane32_swap_b32 v72, v24
    v_permlane32_swap_b32 v73, v25
    v_permlane32_swap_b32 v74, v26
    v_permlane32_swap_b32 v75, v27
    s_nop 1
    v_mov_b32 v8, v72 quad_perm:[0,0,2,2] row_mask:0xf bank_mask:0xf
    v_mov_b32 v9, v73 quad_perm:[0,0,2,2] row_mask:0xf bank_mask:0xf
    v_mov_b32 v10, v74 quad_perm:[0,0,2,2] row_mask:0xf bank_mask:0xf
    v_mov_b32 v11, v75 quad_perm:[0,0,2,2] row_mask:0xf bank_mask:0xf
    v_add_f32 v72, v24, v8 quad_perm:[1,1,3,3] row_mask:0xf bank_mask:0xf
    v_add_f32 v73, v25, v9 quad_perm:[1,1,3,3] row_mask:0xf bank_mask:0xf
    v_add_f32 v74, v26, v10 quad_perm:[1,1,3,3] row_mask:0xf bank_mask:0xf
    v_add_f32 v75, v27, v11 quad_perm:[1,1,3,3] row_mask:0xf bank_mask:0xf
    s_nop 7
    s_nop 3
    v_permlane32_swap_b32 v76, v28
    v_permlane32_swap_b32 v77, v29
    v_permlane32_swap_b32 v78, v30
    v_permlane32_swap_b32 v79, v31
    s_nop 1
    v_mov_b32 v8, v76 quad_perm:[0,0,2,2] row_mask:0xf bank_mask:0xf
    v_mov_b32 v9, v77 quad_perm:[0,0,2,2] row_mask:0xf bank_mask:0xf
    v_mov_b32 v10, v78 quad_perm:[0,0,2,2] row_mask:0xf bank_mask:0xf
    v_mov_b32 v11, v79 quad_perm:[0,0,2,2] row_mask:0xf bank_mask:0xf
    v_add_f32 v76, v28, v8 quad_perm:[1,1,3,3] row_mask:0xf bank_mask:0xf
    v_add_f32 v77, v29, v9 quad_perm:[1,1,3,3] row_mask:0xf bank_mask:0xf
    v_add_f32 v78, v30, v10 quad_perm:[1,1,3,3] row_mask:0xf bank_mask:0xf
    v_add_f32 v79, v31, v11 quad_perm:[1,1,3,3] row_mask:0xf bank_mask:0xf
    s_lshl_b32 s50, s4, 19
    s_lshl_b32 s53, s6, 15
    s_add_u32 s50, s50, s53
    v_lshlrev_b32 v6, 1, v0
    s_add_u32 s53, s50, 0
    buffer_load_ushort v232, v6, s[20:23], s53 offen offset:0
    buffer_load_ushort v80, v6, s[20:23], s53 offen offset:1024
    buffer_load_ushort v233, v6, s[20:23], s53 offen offset:2048
    buffer_load_ushort v81, v6, s[20:23], s53 offen offset:3072
    s_add_u32 s53, s50, 4096
    buffer_load_ushort v234, v6, s[20:23], s53 offen offset:0
    buffer_load_ushort v82, v6, s[20:23], s53 offen offset:1024
    buffer_load_ushort v235, v6, s[20:23], s53 offen offset:2048
    buffer_load_ushort v83, v6, s[20:23], s53 offen offset:3072
    s_add_u32 s53, s50, 8192
    buffer_load_ushort v236, v6, s[20:23], s53 offen offset:0
    buffer_load_ushort v84, v6, s[20:23], s53 offen offset:1024
    buffer_load_ushort v237, v6, s[20:23], s53 offen offset:2048
    buffer_load_ushort v85, v6, s[20:23], s53 offen offset:3072
    s_add_u32 s53, s50, 12288
    buffer_load_ushort v238, v6, s[20:23], s53 offen offset:0
    buffer_load_ushort v86, v6, s[20:23], s53 offen offset:1024
    buffer_load_ushort v239, v6, s[20:23], s53 offen offset:2048
    buffer_load_ushort v87, v6, s[20:23], s53 offen offset:3072
    s_add_u32 s53, s50, 16384
    buffer_load_ushort v240, v6, s[20:23], s53 offen offset:0
    buffer_load_ushort v88, v6, s[20:23], s53 offen offset:1024
    buffer_load_ushort v241, v6, s[20:23], s53 offen offset:2048
    buffer_load_ushort v89, v6, s[20:23], s53 offen offset:3072
    s_add_u32 s53, s50, 20480
    buffer_load_ushort v242, v6, s[20:23], s53 offen offset:0
    buffer_load_ushort v90, v6, s[20:23], s53 offen offset:1024
    buffer_load_ushort v243, v6, s[20:23], s53 offen offset:2048
    buffer_load_ushort v91, v6, s[20:23], s53 offen offset:3072
    s_add_u32 s53, s50, 24576
    buffer_load_ushort v244, v6, s[20:23], s53 offen offset:0
    buffer_load_ushort v92, v6, s[20:23], s53 offen offset:1024
    buffer_load_ushort v245, v6, s[20:23], s53 offen offset:2048
    buffer_load_ushort v93, v6, s[20:23], s53 offen offset:3072
    s_add_u32 s53, s50, 28672
    buffer_load_ushort v246, v6, s[20:23], s53 offen offset:0
    buffer_load_ushort v94, v6, s[20:23], s53 offen offset:1024
    buffer_load_ushort v247, v6, s[20:23], s53 offen offset:2048
    buffer_load_ushort v95, v6, s[20:23], s53 offen offset:3072
    v_mov_b32 v7, 0
    s_lshl_b32 s50, s5, 10
    s_lshl_b32 s53, s51, 3
    s_add_u32 s50, s50, s53
    buffer_load_dwordx2 v[250:251], v7, s[24:27], s50 offen
    s_nop 7
    v_max3_f32 v8, v40, v41, v42
    v_max3_f32 v9, v43, v44, v45
    v_max3_f32 v8, v8, v46, v47
    v_max3_f32 v9, v9, v48, v49
    v_max3_f32 v8, v8, v50, v51
    v_max3_f32 v9, v9, v52, v53
    v_max3_f32 v8, v8, v54, v55
    v_max3_f32 v9, v9, v56, v57
    v_max3_f32 v8, v8, v58, v59
    v_max3_f32 v9, v9, v60, v61
    v_max3_f32 v8, v8, v62, v63
    v_max3_f32 v9, v9, v64, v65
    v_max3_f32 v8, v8, v66, v67
    v_max3_f32 v9, v9, v68, v69
    v_max3_f32 v8, v8, v70, v71
    v_max3_f32 v9, v9, v72, v73
    v_max3_f32 v8, v8, v74, v75
    v_max3_f32 v9, v9, v76, v77
    v_max3_f32 v8, v8, v78, v79
    v_max_f32 v8, v8, v9
    v_mov_b32 v9, v8
    s_nop 1
    v_permlane16_swap_b32 v8, v9
    s_nop 1
    v_max_f32 v8, v8, v9
    v_mov_b32 v9, v8
    s_nop 1
    v_permlane32_swap_b32 v8, v9
    s_nop 1
    v_max_f32 v8, v8, v9
    v_mov_b32 v249, v8
    v_mul_f32 v10, s52, v8
    v_sub_f32 v10, 0, v10
    v_fma_f32 v40, v40, s52, v10
    v_fma_f32 v41, v41, s52, v10
    v_fma_f32 v42, v42, s52, v10
    v_fma_f32 v43, v43, s52, v10
    v_fma_f32 v44, v44, s52, v10
    v_fma_f32 v45, v45, s52, v10
    v_fma_f32 v46, v46, s52, v10
    v_fma_f32 v47, v47, s52, v10
    v_fma_f32 v48, v48, s52, v10
    v_fma_f32 v49, v49, s52, v10
    v_fma_f32 v50, v50, s52, v10
    v_fma_f32 v51, v51, s52, v10
    v_fma_f32 v52, v52, s52, v10
    v_fma_f32 v53, v53, s52, v10
    v_fma_f32 v54, v54, s52, v10
    v_fma_f32 v55, v55, s52, v10
    v_fma_f32 v56, v56, s52, v10
    v_fma_f32 v57, v57, s52, v10
    v_fma_f32 v58, v58, s52, v10
    v_fma_f32 v59, v59, s52, v10
    v_fma_f32 v60, v60, s52, v10
    v_fma_f32 v61, v61, s52, v10
    v_fma_f32 v62, v62, s52, v10
    v_fma_f32 v63, v63, s52, v10
    v_fma_f32 v64, v64, s52, v10
    v_fma_f32 v65, v65, s52, v10
    v_fma_f32 v66, v66, s52, v10
    v_fma_f32 v67, v67, s52, v10
    v_fma_f32 v68, v68, s52, v10
    v_fma_f32 v69, v69, s52, v10
    v_fma_f32 v70, v70, s52, v10
    v_fma_f32 v71, v71, s52, v10
    v_fma_f32 v72, v72, s52, v10
    v_fma_f32 v73, v73, s52, v10
    v_fma_f32 v74, v74, s52, v10
    v_fma_f32 v75, v75, s52, v10
    v_fma_f32 v76, v76, s52, v10
    v_fma_f32 v77, v77, s52, v10
    v_fma_f32 v78, v78, s52, v10
    v_fma_f32 v79, v79, s52, v10
    v_exp_f32 v40, v40
    v_exp_f32 v41, v41
    v_exp_f32 v42, v42
    v_exp_f32 v43, v43
    v_exp_f32 v44, v44
    v_exp_f32 v45, v45
    v_exp_f32 v46, v46
    v_exp_f32 v47, v47
    v_exp_f32 v48, v48
    v_exp_f32 v49, v49
    v_exp_f32 v50, v50
    v_exp_f32 v51, v51
    v_exp_f32 v52, v52
    v_exp_f32 v53, v53
    v_exp_f32 v54, v54
    v_exp_f32 v55, v55
    v_exp_f32 v56, v56
    v_exp_f32 v57, v57
    v_exp_f32 v58, v58
    v_exp_f32 v59, v59
    v_exp_f32 v60, v60
    v_exp_f32 v61, v61
    v_exp_f32 v62, v62
    v_exp_f32 v63, v63
    v_exp_f32 v64, v64
    v_exp_f32 v65, v65
    v_exp_f32 v66, v66
    v_exp_f32 v67, v67
    v_exp_f32 v68, v68
    v_exp_f32 v69, v69
    v_exp_f32 v70, v70
    v_exp_f32 v71, v71
    v_exp_f32 v72, v72
    v_exp_f32 v73, v73
    v_exp_f32 v74, v74
    v_exp_f32 v75, v75
    v_exp_f32 v76, v76
    v_exp_f32 v77, v77
    v_exp_f32 v78, v78
    v_exp_f32 v79, v79
    s_nop 0
    v_add_f32 v12, v40, v44
    v_add_f32 v13, v41, v45
    v_add_f32 v14, v42, v46
    v_add_f32 v15, v43, v47
    v_add_f32 v12, v12, v48
    v_add_f32 v13, v13, v49
    v_add_f32 v14, v14, v50
    v_add_f32 v15, v15, v51
    v_add_f32 v12, v12, v52
    v_add_f32 v13, v13, v53
    v_add_f32 v14, v14, v54
    v_add_f32 v15, v15, v55
    v_add_f32 v12, v12, v56
    v_add_f32 v13, v13, v57
    v_add_f32 v14, v14, v58
    v_add_f32 v15, v15, v59
    v_add_f32 v12, v12, v60
    v_add_f32 v13, v13, v61
    v_add_f32 v14, v14, v62
    v_add_f32 v15, v15, v63
    v_add_f32 v12, v12, v64
    v_add_f32 v13, v13, v65
    v_add_f32 v14, v14, v66
    v_add_f32 v15, v15, v67
    v_add_f32 v12, v12, v68
    v_add_f32 v13, v13, v69
    v_add_f32 v14, v14, v70
    v_add_f32 v15, v15, v71
    v_add_f32 v12, v12, v72
    v_add_f32 v13, v13, v73
    v_add_f32 v14, v14, v74
    v_add_f32 v15, v15, v75
    v_add_f32 v12, v12, v76
    v_add_f32 v13, v13, v77
    v_add_f32 v14, v14, v78
    v_add_f32 v15, v15, v79
    v_add_f32 v12, v12, v13
    v_add_f32 v14, v14, v15
    v_add_f32 v12, v12, v14
    v_mov_b32 v13, v12
    s_nop 1
    v_permlane16_swap_b32 v12, v13
    s_nop 1
    v_add_f32 v12, v12, v13
    v_mov_b32 v13, v12
    s_nop 1
    v_permlane32_swap_b32 v12, v13
    s_nop 1
    v_add_f32 v12, v12, v13
    v_mov_b32 v252, v12
    v_cvt_pk_bf16_f32 v9, v40, v40
    v_and_b32 v8, v9, v4
    v_and_b32 v9, v9, v5
    v_cvt_pk_bf16_f32 v11, v41, v41
    v_and_b32 v10, v11, v4
    v_and_b32 v11, v11, v5
    s_waitcnt vmcnt(63)
    v_mfma_f32_16x16x16_bf16 v[32:35], v[8:9], v[144:145], 0
    v_mfma_f32_16x16x16_bf16 v[36:39], v[8:9], v[146:147], 0
    buffer_load_dwordx4 v[144:147], v3, s[12:15], s49 offen offset:768 nt
    v_cvt_pk_bf16_f32 v13, v42, v42
    v_and_b32 v12, v13, v4
    v_and_b32 v13, v13, v5
    s_waitcnt vmcnt(63)
    v_mfma_f32_16x16x16_bf16 v[32:35], v[10:11], v[148:149], v[32:35]
    v_mfma_f32_16x16x16_bf16 v[36:39], v[10:11], v[150:151], v[36:39]
    s_mov_b32 s49, 32768
    buffer_load_dwordx4 v[148:151], v3, s[12:15], s49 offen offset:0 nt
    v_cvt_pk_bf16_f32 v15, v43, v43
    v_and_b32 v14, v15, v4
    v_and_b32 v15, v15, v5
    s_waitcnt vmcnt(63)
    v_mfma_f32_16x16x16_bf16 v[32:35], v[12:13], v[152:153], v[32:35]
    v_mfma_f32_16x16x16_bf16 v[36:39], v[12:13], v[154:155], v[36:39]
    buffer_load_dwordx4 v[152:155], v3, s[12:15], s49 offen offset:256 nt
    v_cvt_pk_bf16_f32 v9, v44, v44
    v_and_b32 v8, v9, v4
    v_and_b32 v9, v9, v5
    s_waitcnt vmcnt(63)
    v_mfma_f32_16x16x16_bf16 v[32:35], v[14:15], v[156:157], v[32:35]
    v_mfma_f32_16x16x16_bf16 v[36:39], v[14:15], v[158:159], v[36:39]
    buffer_load_dwordx4 v[156:159], v3, s[12:15], s49 offen offset:512 nt
    v_cvt_pk_bf16_f32 v11, v45, v45
    v_and_b32 v10, v11, v4
    v_and_b32 v11, v11, v5
    s_waitcnt vmcnt(63)
    v_mfma_f32_16x16x16_bf16 v[32:35], v[8:9], v[160:161], v[32:35]
    v_mfma_f32_16x16x16_bf16 v[36:39], v[8:9], v[162:163], v[36:39]
    buffer_load_dwordx4 v[160:163], v3, s[12:15], s49 offen offset:768 nt
    v_cvt_pk_bf16_f32 v13, v46, v46
    v_and_b32 v12, v13, v4
    v_and_b32 v13, v13, v5
    s_waitcnt vmcnt(63)
    v_mfma_f32_16x16x16_bf16 v[32:35], v[10:11], v[164:165], v[32:35]
    v_mfma_f32_16x16x16_bf16 v[36:39], v[10:11], v[166:167], v[36:39]
    s_mov_b32 s49, 36864
    buffer_load_dwordx4 v[164:167], v3, s[12:15], s49 offen offset:0 nt
    v_cvt_pk_bf16_f32 v15, v47, v47
    v_and_b32 v14, v15, v4
    v_and_b32 v15, v15, v5
    s_waitcnt vmcnt(63)
    v_mfma_f32_16x16x16_bf16 v[32:35], v[12:13], v[168:169], v[32:35]
    v_mfma_f32_16x16x16_bf16 v[36:39], v[12:13], v[170:171], v[36:39]
    buffer_load_dwordx4 v[168:171], v3, s[12:15], s49 offen offset:256 nt
    v_cvt_pk_bf16_f32 v9, v48, v48
    v_and_b32 v8, v9, v4
    v_and_b32 v9, v9, v5
    s_waitcnt vmcnt(63)
    v_mfma_f32_16x16x16_bf16 v[32:35], v[14:15], v[172:173], v[32:35]
    v_mfma_f32_16x16x16_bf16 v[36:39], v[14:15], v[174:175], v[36:39]
    buffer_load_dwordx4 v[172:175], v3, s[12:15], s49 offen offset:512 nt
    v_cvt_pk_bf16_f32 v11, v49, v49
    v_and_b32 v10, v11, v4
    v_and_b32 v11, v11, v5
    s_waitcnt vmcnt(63)
    v_mfma_f32_16x16x16_bf16 v[32:35], v[8:9], v[176:177], v[32:35]
    v_mfma_f32_16x16x16_bf16 v[36:39], v[8:9], v[178:179], v[36:39]
    buffer_load_dwordx4 v[176:179], v3, s[12:15], s49 offen offset:768 nt
    v_cvt_pk_bf16_f32 v13, v50, v50
    v_and_b32 v12, v13, v4
    v_and_b32 v13, v13, v5
    s_waitcnt vmcnt(63)
    v_mfma_f32_16x16x16_bf16 v[32:35], v[10:11], v[180:181], v[32:35]
    v_mfma_f32_16x16x16_bf16 v[36:39], v[10:11], v[182:183], v[36:39]
    v_cvt_pk_bf16_f32 v15, v51, v51
    v_and_b32 v14, v15, v4
    v_and_b32 v15, v15, v5
    s_waitcnt vmcnt(62)
    v_mfma_f32_16x16x16_bf16 v[32:35], v[12:13], v[184:185], v[32:35]
    v_mfma_f32_16x16x16_bf16 v[36:39], v[12:13], v[186:187], v[36:39]
    v_cvt_pk_bf16_f32 v9, v52, v52
    v_and_b32 v8, v9, v4
    v_and_b32 v9, v9, v5
    s_waitcnt vmcnt(61)
    v_mfma_f32_16x16x16_bf16 v[32:35], v[14:15], v[188:189], v[32:35]
    v_mfma_f32_16x16x16_bf16 v[36:39], v[14:15], v[190:191], v[36:39]
    v_cvt_pk_bf16_f32 v11, v53, v53
    v_and_b32 v10, v11, v4
    v_and_b32 v11, v11, v5
    s_waitcnt vmcnt(60)
    v_mfma_f32_16x16x16_bf16 v[32:35], v[8:9], v[192:193], v[32:35]
    v_mfma_f32_16x16x16_bf16 v[36:39], v[8:9], v[194:195], v[36:39]
    v_cvt_pk_bf16_f32 v13, v54, v54
    v_and_b32 v12, v13, v4
    v_and_b32 v13, v13, v5
    s_waitcnt vmcnt(59)
    v_mfma_f32_16x16x16_bf16 v[32:35], v[10:11], v[196:197], v[32:35]
    v_mfma_f32_16x16x16_bf16 v[36:39], v[10:11], v[198:199], v[36:39]
    v_cvt_pk_bf16_f32 v15, v55, v55
    v_and_b32 v14, v15, v4
    v_and_b32 v15, v15, v5
    s_waitcnt vmcnt(58)
    v_mfma_f32_16x16x16_bf16 v[32:35], v[12:13], v[200:201], v[32:35]
    v_mfma_f32_16x16x16_bf16 v[36:39], v[12:13], v[202:203], v[36:39]
    v_cvt_pk_bf16_f32 v9, v56, v56
    v_and_b32 v8, v9, v4
    v_and_b32 v9, v9, v5
    s_waitcnt vmcnt(57)
    v_mfma_f32_16x16x16_bf16 v[32:35], v[14:15], v[204:205], v[32:35]
    v_mfma_f32_16x16x16_bf16 v[36:39], v[14:15], v[206:207], v[36:39]
    v_cvt_pk_bf16_f32 v11, v57, v57
    v_and_b32 v10, v11, v4
    v_and_b32 v11, v11, v5
    s_waitcnt vmcnt(56)
    v_mfma_f32_16x16x16_bf16 v[32:35], v[8:9], v[208:209], v[32:35]
    v_mfma_f32_16x16x16_bf16 v[36:39], v[8:9], v[210:211], v[36:39]
    v_cvt_pk_bf16_f32 v13, v58, v58
    v_and_b32 v12, v13, v4
    v_and_b32 v13, v13, v5
    s_waitcnt vmcnt(55)
    v_mfma_f32_16x16x16_bf16 v[32:35], v[10:11], v[212:213], v[32:35]
    v_mfma_f32_16x16x16_bf16 v[36:39], v[10:11], v[214:215], v[36:39]
    v_cvt_pk_bf16_f32 v15, v59, v59
    v_and_b32 v14, v15, v4
    v_and_b32 v15, v15, v5
    s_waitcnt vmcnt(54)
    v_mfma_f32_16x16x16_bf16 v[32:35], v[12:13], v[216:217], v[32:35]
    v_mfma_f32_16x16x16_bf16 v[36:39], v[12:13], v[218:219], v[36:39]
    v_cvt_pk_bf16_f32 v9, v60, v60
    v_and_b32 v8, v9, v4
    v_and_b32 v9, v9, v5
    s_waitcnt vmcnt(53)
    v_mfma_f32_16x16x16_bf16 v[32:35], v[14:15], v[220:221], v[32:35]
    v_mfma_f32_16x16x16_bf16 v[36:39], v[14:15], v[222:223], v[36:39]
    v_cvt_pk_bf16_f32 v11, v61, v61
    v_and_b32 v10, v11, v4
    v_and_b32 v11, v11, v5
    s_waitcnt vmcnt(52)
    v_mfma_f32_16x16x16_bf16 v[32:35], v[8:9], v[224:225], v[32:35]
    v_mfma_f32_16x16x16_bf16 v[36:39], v[8:9], v[226:227], v[36:39]
    v_cvt_pk_bf16_f32 v13, v62, v62
    v_and_b32 v12, v13, v4
    v_and_b32 v13, v13, v5
    s_waitcnt vmcnt(51)
    v_mfma_f32_16x16x16_bf16 v[32:35], v[10:11], v[228:229], v[32:35]
    v_mfma_f32_16x16x16_bf16 v[36:39], v[10:11], v[230:231], v[36:39]
    v_cvt_pk_bf16_f32 v15, v63, v63
    v_and_b32 v14, v15, v4
    v_and_b32 v15, v15, v5
    s_waitcnt vmcnt(50)
    v_mfma_f32_16x16x16_bf16 v[32:35], v[12:13], v[108:109], v[32:35]
    v_mfma_f32_16x16x16_bf16 v[36:39], v[12:13], v[110:111], v[36:39]
    v_cvt_pk_bf16_f32 v9, v64, v64
    v_and_b32 v8, v9, v4
    v_and_b32 v9, v9, v5
    s_waitcnt vmcnt(49)
    v_mfma_f32_16x16x16_bf16 v[32:35], v[14:15], v[112:113], v[32:35]
    v_mfma_f32_16x16x16_bf16 v[36:39], v[14:15], v[114:115], v[36:39]
    v_cvt_pk_bf16_f32 v11, v65, v65
    v_and_b32 v10, v11, v4
    v_and_b32 v11, v11, v5
    s_waitcnt vmcnt(48)
    v_mfma_f32_16x16x16_bf16 v[32:35], v[8:9], v[116:117], v[32:35]
    v_mfma_f32_16x16x16_bf16 v[36:39], v[8:9], v[118:119], v[36:39]
    v_cvt_pk_bf16_f32 v13, v66, v66
    v_and_b32 v12, v13, v4
    v_and_b32 v13, v13, v5
    s_waitcnt vmcnt(47)
    v_mfma_f32_16x16x16_bf16 v[32:35], v[10:11], v[120:121], v[32:35]
    v_mfma_f32_16x16x16_bf16 v[36:39], v[10:11], v[122:123], v[36:39]
    v_cvt_pk_bf16_f32 v15, v67, v67
    v_and_b32 v14, v15, v4
    v_and_b32 v15, v15, v5
    s_waitcnt vmcnt(46)
    v_mfma_f32_16x16x16_bf16 v[32:35], v[12:13], v[124:125], v[32:35]
    v_mfma_f32_16x16x16_bf16 v[36:39], v[12:13], v[126:127], v[36:39]
    v_cvt_pk_bf16_f32 v9, v68, v68
    v_and_b32 v8, v9, v4
    v_and_b32 v9, v9, v5
    s_waitcnt vmcnt(45)
    v_mfma_f32_16x16x16_bf16 v[32:35], v[14:15], v[128:129], v[32:35]
    v_mfma_f32_16x16x16_bf16 v[36:39], v[14:15], v[130:131], v[36:39]
    v_cvt_pk_bf16_f32 v11, v69, v69
    v_and_b32 v10, v11, v4
    v_and_b32 v11, v11, v5
    s_waitcnt vmcnt(44)
    v_mfma_f32_16x16x16_bf16 v[32:35], v[8:9], v[132:133], v[32:35]
    v_mfma_f32_16x16x16_bf16 v[36:39], v[8:9], v[134:135], v[36:39]
    v_cvt_pk_bf16_f32 v13, v70, v70
    v_and_b32 v12, v13, v4
    v_and_b32 v13, v13, v5
    s_waitcnt vmcnt(43)
    v_mfma_f32_16x16x16_bf16 v[32:35], v[10:11], v[136:137], v[32:35]
    v_mfma_f32_16x16x16_bf16 v[36:39], v[10:11], v[138:139], v[36:39]
    v_cvt_pk_bf16_f32 v15, v71, v71
    v_and_b32 v14, v15, v4
    v_and_b32 v15, v15, v5
    s_waitcnt vmcnt(42)
    v_mfma_f32_16x16x16_bf16 v[32:35], v[12:13], v[140:141], v[32:35]
    v_mfma_f32_16x16x16_bf16 v[36:39], v[12:13], v[142:143], v[36:39]
    v_cvt_pk_bf16_f32 v9, v72, v72
    v_and_b32 v8, v9, v4
    v_and_b32 v9, v9, v5
    s_waitcnt vmcnt(8)
    v_mfma_f32_16x16x16_bf16 v[32:35], v[14:15], v[144:145], v[32:35]
    v_mfma_f32_16x16x16_bf16 v[36:39], v[14:15], v[146:147], v[36:39]
    v_cvt_pk_bf16_f32 v11, v73, v73
    v_and_b32 v10, v11, v4
    v_and_b32 v11, v11, v5
    s_waitcnt vmcnt(7)
    v_mfma_f32_16x16x16_bf16 v[32:35], v[8:9], v[148:149], v[32:35]
    v_mfma_f32_16x16x16_bf16 v[36:39], v[8:9], v[150:151], v[36:39]
    v_cvt_pk_bf16_f32 v13, v74, v74
    v_and_b32 v12, v13, v4
    v_and_b32 v13, v13, v5
    s_waitcnt vmcnt(6)
    v_mfma_f32_16x16x16_bf16 v[32:35], v[10:11], v[152:153], v[32:35]
    v_mfma_f32_16x16x16_bf16 v[36:39], v[10:11], v[154:155], v[36:39]
    v_lshl_or_b32 v232, v80, 16, v232
    v_lshl_or_b32 v233, v81, 16, v233
    v_lshl_or_b32 v234, v82, 16, v234
    v_lshl_or_b32 v235, v83, 16, v235
    v_lshl_or_b32 v236, v84, 16, v236
    v_lshl_or_b32 v237, v85, 16, v237
    v_lshl_or_b32 v238, v86, 16, v238
    v_lshl_or_b32 v239, v87, 16, v239
    v_lshl_or_b32 v240, v88, 16, v240
    v_lshl_or_b32 v241, v89, 16, v241
    v_lshl_or_b32 v242, v90, 16, v242
    v_lshl_or_b32 v243, v91, 16, v243
    v_lshl_or_b32 v244, v92, 16, v244
    v_lshl_or_b32 v245, v93, 16, v245
    v_lshl_or_b32 v246, v94, 16, v246
    v_lshl_or_b32 v247, v95, 16, v247
    v_cvt_pk_bf16_f32 v15, v75, v75
    v_and_b32 v14, v15, v4
    v_and_b32 v15, v15, v5
    s_waitcnt vmcnt(5)
    v_mfma_f32_16x16x16_bf16 v[32:35], v[12:13], v[156:157], v[32:35]
    v_mfma_f32_16x16x16_bf16 v[36:39], v[12:13], v[158:159], v[36:39]
    buffer_load_dword v253, v248, s[40:43], 0 offen sc0 sc1
    v_cvt_pk_bf16_f32 v9, v76, v76
    v_and_b32 v8, v9, v4
    v_and_b32 v9, v9, v5
    s_waitcnt vmcnt(4)
    v_mfma_f32_16x16x16_bf16 v[32:35], v[14:15], v[160:161], v[32:35]
    v_mfma_f32_16x16x16_bf16 v[36:39], v[14:15], v[162:163], v[36:39]
    v_cvt_pk_bf16_f32 v11, v77, v77
    v_and_b32 v10, v11, v4
    v_and_b32 v11, v11, v5
    s_waitcnt vmcnt(3)
    v_mfma_f32_16x16x16_bf16 v[32:35], v[8:9], v[164:165], v[32:35]
    v_mfma_f32_16x16x16_bf16 v[36:39], v[8:9], v[166:167], v[36:39]
    v_cvt_pk_bf16_f32 v13, v78, v78
    v_and_b32 v12, v13, v4
    v_and_b32 v13, v13, v5
    s_waitcnt vmcnt(2)
    v_mfma_f32_16x16x16_bf16 v[32:35], v[10:11], v[168:169], v[32:35]
    v_mfma_f32_16x16x16_bf16 v[36:39], v[10:11], v[170:171], v[36:39]
    v_cvt_pk_bf16_f32 v15, v79, v79
    v_and_b32 v14, v15, v4
    v_and_b32 v15, v15, v5
    s_waitcnt vmcnt(1)
    v_mfma_f32_16x16x16_bf16 v[32:35], v[12:13], v[172:173], v[32:35]
    v_mfma_f32_16x16x16_bf16 v[36:39], v[12:13], v[174:175], v[36:39]
    s_nop 1
    s_waitcnt vmcnt(0)
    v_mfma_f32_16x16x16_bf16 v[32:35], v[14:15], v[176:177], v[32:35]
    v_mfma_f32_16x16x16_bf16 v[36:39], v[14:15], v[178:179], v[36:39]
    s_mov_b32 s54, 262144
L_DFC:
    s_waitcnt vmcnt(0)
    s_mov_b32 s53, 0x02020202
    v_and_b32 v253, s53, v253
    v_cmp_ne_u32 vcc, s53, v253
    s_cbranch_vccz L_DFC_OK
    s_sub_u32 s54, s54, 1
    s_cmp_eq_u32 s54, 0
    s_cbranch_scc1 L_DFC_OK
    s_sleep 1
    buffer_load_dword v253, v248, s[40:43], 0 offen sc0 sc1
    s_branch L_DFC
L_DFC_OK:
    s_lshl_b32 s33, s60, 16
    s_add_u32 s33, s33, 192
    s_lshl_b32 s32, s5, 26
    s_lshl_b32 s50, s4, 23
    s_add_u32 s32, s32, s50
    v_mov_b32 v44, 1
    s_mov_b64 exec, 1
    buffer_atomic_add v44, v254, s[44:47], s33 offen sc0 sc1
    s_mov_b64 exec, -1
    v_mov_b32 v45, 1
    s_mov_b64 exec, 1
    buffer_atomic_add v45, v254, s[44:47], s33 offen sc0 sc1
    s_mov_b64 exec, -1
    s_add_u32 s16, s66, s32
    s_addc_u32 s17, s67, 0
    s_mov_b32 s18, 0x800000
    s_mov_b32 s19, 0x00020000
    s_add_u32 s28, s68, s32
    s_addc_u32 s29, s69, 0
    s_mov_b32 s30, 0x800000
    s_mov_b32 s31, 0x00020000
    v_subrev_u32 v6, s57, v2
    v_subrev_u32 v7, s57, v3
    s_mov_b32 s58, 0xffff0000
    s_mov_b32 s59, -1
    s_mov_b32 s60, 0
    s_mov_b32 s61, -1
    s_mov_b32 s62, 0
    s_mov_b32 s63, 0xffff0000
    s_waitcnt vmcnt(0)
    v_add_u32 v46, 1, v44
    v_add_u32 v47, 1, v45
    v_min_u32 v44, v46, v47
    v_max_u32 v45, v46, v47
    v_add_u32 v44, -1, v44
    v_add_u32 v45, -1, v45
    s_nop 1
    v_readfirstlane_b32 s48, v44
    s_add_u32 s48, s48, 1
    s_cmp_ge_u32 s48, 416
    s_cbranch_scc1 L_DDONE
    s_add_u32 s48, s48, 1632
    s_lshl_b32 s48, s48, 12
    buffer_load_dwordx4 v[104:107], v6, s[16:19], s48 offen offset:0 nt
    buffer_load_dwordx4 v[108:111], v6, s[16:19], s48 offen offset:128 nt
    buffer_load_dwordx4 v[112:115], v6, s[16:19], s48 offen offset:2048 nt
    buffer_load_dwordx4 v[116:119], v6, s[16:19], s48 offen offset:2176 nt
    buffer_load_dwordx4 v[120:123], v7, s[28:31], s48 offen offset:0 nt
    buffer_load_dwordx4 v[124:127], v7, s[28:31], s48 offen offset:256 nt
    buffer_load_dwordx4 v[128:131], v7, s[28:31], s48 offen offset:512 nt
    buffer_load_dwordx4 v[132:135], v7, s[28:31], s48 offen offset:768 nt
    v_readfirstlane_b32 s49, v45
    s_add_u32 s49, s49, 1
    s_cmp_ge_u32 s49, 416
    s_cbranch_scc1 L_DLAST_X
    s_add_u32 s49, s49, 1632
    s_lshl_b32 s49, s49, 12
    v_mov_b32 v44, 1
    s_mov_b64 exec, 1
    buffer_atomic_add v44, v254, s[44:47], s33 offen sc0 sc1
    s_mov_b64 exec, -1
    buffer_load_dwordx4 v[136:139], v6, s[16:19], s49 offen offset:0 nt
    buffer_load_dwordx4 v[140:143], v6, s[16:19], s49 offen offset:128 nt
    buffer_load_dwordx4 v[144:147], v6, s[16:19], s49 offen offset:2048 nt
    buffer_load_dwordx4 v[148:151], v6, s[16:19], s49 offen offset:2176 nt
    buffer_load_dwordx4 v[152:155], v7, s[28:31], s49 offen offset:0 nt
    buffer_load_dwordx4 v[156:159], v7, s[28:31], s49 offen offset:256 nt
    buffer_load_dwordx4 v[160:163], v7, s[28:31], s49 offen offset:512 nt
    buffer_load_dwordx4 v[164:167], v7, s[28:31], s49 offen offset:768 nt
L_DLOOP:
    s_waitcnt vmcnt(8)
    v_readfirstlane_b32 s48, v44
    s_add_u32 s48, s48, 1
    s_cmp_ge_u32 s48, 416
    s_cbranch_scc1 L_DLAST_XY
    s_add_u32 s48, s48, 1632
    s_lshl_b32 s48, s48, 12
    v_mov_b32 v45, 1
    s_mov_b64 exec, 1
    buffer_atomic_add v45, v254, s[44:47], s33 offen sc0 sc1
    s_mov_b64 exec, -1
    v_mfma_f32_16x16x32_bf16 v[40:43], v[104:107], v[16:19], 0
    v_mfma_f32_16x16x32_bf16 v[24:27], v[112:115], v[16:19], 0
    v_mfma_f32_16x16x32_bf16 v[40:43], v[108:111], v[20:23], v[40:43]
    v_mfma_f32_16x16x32_bf16 v[24:27], v[116:119], v[20:23], v[24:27]
    buffer_load_dwordx4 v[104:107], v6, s[16:19], s48 offen offset:0 nt
    buffer_load_dwordx4 v[108:111], v6, s[16:19], s48 offen offset:128 nt
    buffer_load_dwordx4 v[112:115], v6, s[16:19], s48 offen offset:2048 nt
    buffer_load_dwordx4 v[116:119], v6, s[16:19], s48 offen offset:2176 nt
    s_nop 7
    s_nop 3
    v_permlane32_swap_b32 v40, v24
    v_permlane32_swap_b32 v41, v25
    v_permlane32_swap_b32 v42, v26
    v_permlane32_swap_b32 v43, v27
    s_nop 1
    v_mov_b32 v8, v40 quad_perm:[0,0,2,2] row_mask:0xf bank_mask:0xf
    v_mov_b32 v9, v41 quad_perm:[0,0,2,2] row_mask:0xf bank_mask:0xf
    v_mov_b32 v10, v42 quad_perm:[0,0,2,2] row_mask:0xf bank_mask:0xf
    v_mov_b32 v11, v43 quad_perm:[0,0,2,2] row_mask:0xf bank_mask:0xf
    v_add_f32 v40, v24, v8 quad_perm:[1,1,3,3] row_mask:0xf bank_mask:0xf
    v_add_f32 v41, v25, v9 quad_perm:[1,1,3,3] row_mask:0xf bank_mask:0xf
    v_add_f32 v42, v26, v10 quad_perm:[1,1,3,3] row_mask:0xf bank_mask:0xf
    v_add_f32 v43, v27, v11 quad_perm:[1,1,3,3] row_mask:0xf bank_mask:0xf
    v_max3_f32 v8, v40, v41, v42
    v_max3_f32 v8, v8, v43, v249
    v_mov_b32 v9, v8
    s_nop 1
    v_permlane16_swap_b32 v8, v9
    s_nop 1
    v_max_f32 v8, v8, v9
    v_mov_b32 v9, v8
    s_nop 1
    v_permlane32_swap_b32 v8, v9
    s_nop 1
    v_max_f32 v8, v8, v9
    v_sub_f32 v11, v249, v8
    v_mul_f32 v11, s52, v11
    v_exp_f32 v11, v11
    v_mov_b32 v249, v8
    v_mul_f32 v10, s52, v8
    v_sub_f32 v10, 0, v10
    v_fma_f32 v40, v40, s52, v10
    v_fma_f32 v41, v41, s52, v10
    v_fma_f32 v42, v42, s52, v10
    v_fma_f32 v43, v43, s52, v10
    v_exp_f32 v40, v40
    v_exp_f32 v41, v41
    v_exp_f32 v42, v42
    v_exp_f32 v43, v43
    v_readlane_b32 s34, v11, 0
    v_readlane_b32 s35, v11, 4
    v_readlane_b32 s36, v11, 8
    v_readlane_b32 s37, v11, 12
    v_add_f32 v12, v40, v41
    v_add_f32 v13, v42, v43
    v_add_f32 v12, v12, v13
    v_mov_b32 v13, v12
    s_nop 1
    v_permlane16_swap_b32 v12, v13
    s_nop 1
    v_add_f32 v12, v12, v13
    v_mov_b32 v13, v12
    s_nop 1
    v_permlane32_swap_b32 v12, v13
    s_nop 1
    v_add_f32 v12, v12, v13
    v_fma_f32 v252, v252, v11, v12
    v_mov_b32 v13, s34
    v_mov_b32 v14, s35
    v_cndmask_b32 v13, v13, v14, s[58:59]
    v_mov_b32 v14, s36
    v_cndmask_b32 v13, v13, v14, s[60:61]
    v_mov_b32 v14, s37
    v_cndmask_b32 v13, v13, v14, s[62:63]
    v_mul_f32 v32, v32, v13
    v_mul_f32 v33, v33, v13
    v_mul_f32 v34, v34, v13
    v_mul_f32 v35, v35, v13
    v_mul_f32 v36, v36, v13
    v_mul_f32 v37, v37, v13
    v_mul_f32 v38, v38, v13
    v_mul_f32 v39, v39, v13
    v_cvt_pk_bf16_f32 v9, v40, v40
    v_and_b32 v8, v9, v4
    v_and_b32 v9, v9, v5
    v_cvt_pk_bf16_f32 v11, v41, v41
    v_and_b32 v10, v11, v4
    v_and_b32 v11, v11, v5
    v_mfma_f32_16x16x16_bf16 v[32:35], v[8:9], v[120:121], v[32:35]
    v_mfma_f32_16x16x16_bf16 v[36:39], v[8:9], v[122:123], v[36:39]
    v_cvt_pk_bf16_f32 v13, v42, v42
    v_and_b32 v12, v13, v4
    v_and_b32 v13, v13, v5
    v_mfma_f32_16x16x16_bf16 v[32:35], v[10:11], v[124:125], v[32:35]
    v_mfma_f32_16x16x16_bf16 v[36:39], v[10:11], v[126:127], v[36:39]
    v_cvt_pk_bf16_f32 v15, v43, v43
    v_and_b32 v14, v15, v4
    v_and_b32 v15, v15, v5
    v_mfma_f32_16x16x16_bf16 v[32:35], v[12:13], v[128:129], v[32:35]
    v_mfma_f32_16x16x16_bf16 v[36:39], v[12:13], v[130:131], v[36:39]
    s_nop 1
    v_mfma_f32_16x16x16_bf16 v[32:35], v[14:15], v[132:133], v[32:35]
    v_mfma_f32_16x16x16_bf16 v[36:39], v[14:15], v[134:135], v[36:39]
    buffer_load_dwordx4 v[120:123], v7, s[28:31], s48 offen offset:0 nt
    buffer_load_dwordx4 v[124:127], v7, s[28:31], s48 offen offset:256 nt
    buffer_load_dwordx4 v[128:131], v7, s[28:31], s48 offen offset:512 nt
    buffer_load_dwordx4 v[132:135], v7, s[28:31], s48 offen offset:768 nt
    s_waitcnt vmcnt(8)
    v_readfirstlane_b32 s49, v45
    s_add_u32 s49, s49, 1
    s_cmp_ge_u32 s49, 416
    s_cbranch_scc1 L_DLAST_YX
    s_add_u32 s49, s49, 1632
    s_lshl_b32 s49, s49, 12
    v_mov_b32 v44, 1
    s_mov_b64 exec, 1
    buffer_atomic_add v44, v254, s[44:47], s33 offen sc0 sc1
    s_mov_b64 exec, -1
    v_mfma_f32_16x16x32_bf16 v[40:43], v[136:139], v[16:19], 0
    v_mfma_f32_16x16x32_bf16 v[24:27], v[144:147], v[16:19], 0
    v_mfma_f32_16x16x32_bf16 v[40:43], v[140:143], v[20:23], v[40:43]
    v_mfma_f32_16x16x32_bf16 v[24:27], v[148:151], v[20:23], v[24:27]
    buffer_load_dwordx4 v[136:139], v6, s[16:19], s49 offen offset:0 nt
    buffer_load_dwordx4 v[140:143], v6, s[16:19], s49 offen offset:128 nt
    buffer_load_dwordx4 v[144:147], v6, s[16:19], s49 offen offset:2048 nt
    buffer_load_dwordx4 v[148:151], v6, s[16:19], s49 offen offset:2176 nt
    s_nop 7
    s_nop 3
    v_permlane32_swap_b32 v40, v24
    v_permlane32_swap_b32 v41, v25
    v_permlane32_swap_b32 v42, v26
    v_permlane32_swap_b32 v43, v27
    s_nop 1
    v_mov_b32 v8, v40 quad_perm:[0,0,2,2] row_mask:0xf bank_mask:0xf
    v_mov_b32 v9, v41 quad_perm:[0,0,2,2] row_mask:0xf bank_mask:0xf
    v_mov_b32 v10, v42 quad_perm:[0,0,2,2] row_mask:0xf bank_mask:0xf
    v_mov_b32 v11, v43 quad_perm:[0,0,2,2] row_mask:0xf bank_mask:0xf
    v_add_f32 v40, v24, v8 quad_perm:[1,1,3,3] row_mask:0xf bank_mask:0xf
    v_add_f32 v41, v25, v9 quad_perm:[1,1,3,3] row_mask:0xf bank_mask:0xf
    v_add_f32 v42, v26, v10 quad_perm:[1,1,3,3] row_mask:0xf bank_mask:0xf
    v_add_f32 v43, v27, v11 quad_perm:[1,1,3,3] row_mask:0xf bank_mask:0xf
    v_max3_f32 v8, v40, v41, v42
    v_max3_f32 v8, v8, v43, v249
    v_mov_b32 v9, v8
    s_nop 1
    v_permlane16_swap_b32 v8, v9
    s_nop 1
    v_max_f32 v8, v8, v9
    v_mov_b32 v9, v8
    s_nop 1
    v_permlane32_swap_b32 v8, v9
    s_nop 1
    v_max_f32 v8, v8, v9
    v_sub_f32 v11, v249, v8
    v_mul_f32 v11, s52, v11
    v_exp_f32 v11, v11
    v_mov_b32 v249, v8
    v_mul_f32 v10, s52, v8
    v_sub_f32 v10, 0, v10
    v_fma_f32 v40, v40, s52, v10
    v_fma_f32 v41, v41, s52, v10
    v_fma_f32 v42, v42, s52, v10
    v_fma_f32 v43, v43, s52, v10
    v_exp_f32 v40, v40
    v_exp_f32 v41, v41
    v_exp_f32 v42, v42
    v_exp_f32 v43, v43
    v_readlane_b32 s34, v11, 0
    v_readlane_b32 s35, v11, 4
    v_readlane_b32 s36, v11, 8
    v_readlane_b32 s37, v11, 12
    v_add_f32 v12, v40, v41
    v_add_f32 v13, v42, v43
    v_add_f32 v12, v12, v13
    v_mov_b32 v13, v12
    s_nop 1
    v_permlane16_swap_b32 v12, v13
    s_nop 1
    v_add_f32 v12, v12, v13
    v_mov_b32 v13, v12
    s_nop 1
    v_permlane32_swap_b32 v12, v13
    s_nop 1
    v_add_f32 v12, v12, v13
    v_fma_f32 v252, v252, v11, v12
    v_mov_b32 v13, s34
    v_mov_b32 v14, s35
    v_cndmask_b32 v13, v13, v14, s[58:59]
    v_mov_b32 v14, s36
    v_cndmask_b32 v13, v13, v14, s[60:61]
    v_mov_b32 v14, s37
    v_cndmask_b32 v13, v13, v14, s[62:63]
    v_mul_f32 v32, v32, v13
    v_mul_f32 v33, v33, v13
    v_mul_f32 v34, v34, v13
    v_mul_f32 v35, v35, v13
    v_mul_f32 v36, v36, v13
    v_mul_f32 v37, v37, v13
    v_mul_f32 v38, v38, v13
    v_mul_f32 v39, v39, v13
    v_cvt_pk_bf16_f32 v9, v40, v40
    v_and_b32 v8, v9, v4
    v_and_b32 v9, v9, v5
    v_cvt_pk_bf16_f32 v11, v41, v41
    v_and_b32 v10, v11, v4
    v_and_b32 v11, v11, v5
    v_mfma_f32_16x16x16_bf16 v[32:35], v[8:9], v[152:153], v[32:35]
    v_mfma_f32_16x16x16_bf16 v[36:39], v[8:9], v[154:155], v[36:39]
    v_cvt_pk_bf16_f32 v13, v42, v42
    v_and_b32 v12, v13, v4
    v_and_b32 v13, v13, v5
    v_mfma_f32_16x16x16_bf16 v[32:35], v[10:11], v[156:157], v[32:35]
    v_mfma_f32_16x16x16_bf16 v[36:39], v[10:11], v[158:159], v[36:39]
    v_cvt_pk_bf16_f32 v15, v43, v43
    v_and_b32 v14, v15, v4
    v_and_b32 v15, v15, v5
    v_mfma_f32_16x16x16_bf16 v[32:35], v[12:13], v[160:161], v[32:35]
    v_mfma_f32_16x16x16_bf16 v[36:39], v[12:13], v[162:163], v[36:39]
    s_nop 1
    v_mfma_f32_16x16x16_bf16 v[32:35], v[14:15], v[164:165], v[32:35]
    v_mfma_f32_16x16x16_bf16 v[36:39], v[14:15], v[166:167], v[36:39]
    buffer_load_dwordx4 v[152:155], v7, s[28:31], s49 offen offset:0 nt
    buffer_load_dwordx4 v[156:159], v7, s[28:31], s49 offen offset:256 nt
    buffer_load_dwordx4 v[160:163], v7, s[28:31], s49 offen offset:512 nt
    buffer_load_dwordx4 v[164:167], v7, s[28:31], s49 offen offset:768 nt
    s_branch L_DLOOP
L_DLAST_XY:
    v_mfma_f32_16x16x32_bf16 v[40:43], v[104:107], v[16:19], 0
    v_mfma_f32_16x16x32_bf16 v[24:27], v[112:115], v[16:19], 0
    v_mfma_f32_16x16x32_bf16 v[40:43], v[108:111], v[20:23], v[40:43]
    v_mfma_f32_16x16x32_bf16 v[24:27], v[116:119], v[20:23], v[24:27]
    s_nop 7
    s_nop 7
    v_permlane32_swap_b32 v40, v24
    v_permlane32_swap_b32 v41, v25
    v_permlane32_swap_b32 v42, v26
    v_permlane32_swap_b32 v43, v27
    s_nop 1
    v_mov_b32 v8, v40 quad_perm:[0,0,2,2] row_mask:0xf bank_mask:0xf
    v_mov_b32 v9, v41 quad_perm:[0,0,2,2] row_mask:0xf bank_mask:0xf
    v_mov_b32 v10, v42 quad_perm:[0,0,2,2] row_mask:0xf bank_mask:0xf
    v_mov_b32 v11, v43 quad_perm:[0,0,2,2] row_mask:0xf bank_mask:0xf
    v_add_f32 v40, v24, v8 quad_perm:[1,1,3,3] row_mask:0xf bank_mask:0xf
    v_add_f32 v41, v25, v9 quad_perm:[1,1,3,3] row_mask:0xf bank_mask:0xf
    v_add_f32 v42, v26, v10 quad_perm:[1,1,3,3] row_mask:0xf bank_mask:0xf
    v_add_f32 v43, v27, v11 quad_perm:[1,1,3,3] row_mask:0xf bank_mask:0xf
    v_max3_f32 v8, v40, v41, v42
    v_max3_f32 v8, v8, v43, v249
    v_mov_b32 v9, v8
    s_nop 1
    v_permlane16_swap_b32 v8, v9
    s_nop 1
    v_max_f32 v8, v8, v9
    v_mov_b32 v9, v8
    s_nop 1
    v_permlane32_swap_b32 v8, v9
    s_nop 1
    v_max_f32 v8, v8, v9
    v_sub_f32 v11, v249, v8
    v_mul_f32 v11, s52, v11
    v_exp_f32 v11, v11
    v_mov_b32 v249, v8
    v_mul_f32 v10, s52, v8
    v_sub_f32 v10, 0, v10
    v_fma_f32 v40, v40, s52, v10
    v_fma_f32 v41, v41, s52, v10
    v_fma_f32 v42, v42, s52, v10
    v_fma_f32 v43, v43, s52, v10
    v_exp_f32 v40, v40
    v_exp_f32 v41, v41
    v_exp_f32 v42, v42
    v_exp_f32 v43, v43
    v_readlane_b32 s34, v11, 0
    v_readlane_b32 s35, v11, 4
    v_readlane_b32 s36, v11, 8
    v_readlane_b32 s37, v11, 12
    v_add_f32 v12, v40, v41
    v_add_f32 v13, v42, v43
    v_add_f32 v12, v12, v13
    v_mov_b32 v13, v12
    s_nop 1
    v_permlane16_swap_b32 v12, v13
    s_nop 1
    v_add_f32 v12, v12, v13
    v_mov_b32 v13, v12
    s_nop 1
    v_permlane32_swap_b32 v12, v13
    s_nop 1
    v_add_f32 v12, v12, v13
    v_fma_f32 v252, v252, v11, v12
    v_mov_b32 v13, s34
    v_mov_b32 v14, s35
    v_cndmask_b32 v13, v13, v14, s[58:59]
    v_mov_b32 v14, s36
    v_cndmask_b32 v13, v13, v14, s[60:61]
    v_mov_b32 v14, s37
    v_cndmask_b32 v13, v13, v14, s[62:63]
    v_mul_f32 v32, v32, v13
    v_mul_f32 v33, v33, v13
    v_mul_f32 v34, v34, v13
    v_mul_f32 v35, v35, v13
    v_mul_f32 v36, v36, v13
    v_mul_f32 v37, v37, v13
    v_mul_f32 v38, v38, v13
    v_mul_f32 v39, v39, v13
    v_cvt_pk_bf16_f32 v9, v40, v40
    v_and_b32 v8, v9, v4
    v_and_b32 v9, v9, v5
    v_cvt_pk_bf16_f32 v11, v41, v41
    v_and_b32 v10, v11, v4
    v_and_b32 v11, v11, v5
    v_mfma_f32_16x16x16_bf16 v[32:35], v[8:9], v[120:121], v[32:35]
    v_mfma_f32_16x16x16_bf16 v[36:39], v[8:9], v[122:123], v[36:39]
    v_cvt_pk_bf16_f32 v13, v42, v42
    v_and_b32 v12, v13, v4
    v_and_b32 v13, v13, v5
    v_mfma_f32_16x16x16_bf16 v[32:35], v[10:11], v[124:125], v[32:35]
    v_mfma_f32_16x16x16_bf16 v[36:39], v[10:11], v[126:127], v[36:39]
    v_cvt_pk_bf16_f32 v15, v43, v43
    v_and_b32 v14, v15, v4
    v_and_b32 v15, v15, v5
    v_mfma_f32_16x16x16_bf16 v[32:35], v[12:13], v[128:129], v[32:35]
    v_mfma_f32_16x16x16_bf16 v[36:39], v[12:13], v[130:131], v[36:39]
    s_nop 1
    v_mfma_f32_16x16x16_bf16 v[32:35], v[14:15], v[132:133], v[32:35]
    v_mfma_f32_16x16x16_bf16 v[36:39], v[14:15], v[134:135], v[36:39]
    s_waitcnt vmcnt(0)
    v_mfma_f32_16x16x32_bf16 v[40:43], v[136:139], v[16:19], 0
    v_mfma_f32_16x16x32_bf16 v[24:27], v[144:147], v[16:19], 0
    v_mfma_f32_16x16x32_bf16 v[40:43], v[140:143], v[20:23], v[40:43]
    v_mfma_f32_16x16x32_bf16 v[24:27], v[148:151], v[20:23], v[24:27]
    s_nop 7
    s_nop 7
    v_permlane32_swap_b32 v40, v24
    v_permlane32_swap_b32 v41, v25
    v_permlane32_swap_b32 v42, v26
    v_permlane32_swap_b32 v43, v27
    s_nop 1
    v_mov_b32 v8, v40 quad_perm:[0,0,2,2] row_mask:0xf bank_mask:0xf
    v_mov_b32 v9, v41 quad_perm:[0,0,2,2] row_mask:0xf bank_mask:0xf
    v_mov_b32 v10, v42 quad_perm:[0,0,2,2] row_mask:0xf bank_mask:0xf
    v_mov_b32 v11, v43 quad_perm:[0,0,2,2] row_mask:0xf bank_mask:0xf
    v_add_f32 v40, v24, v8 quad_perm:[1,1,3,3] row_mask:0xf bank_mask:0xf
    v_add_f32 v41, v25, v9 quad_perm:[1,1,3,3] row_mask:0xf bank_mask:0xf
    v_add_f32 v42, v26, v10 quad_perm:[1,1,3,3] row_mask:0xf bank_mask:0xf
    v_add_f32 v43, v27, v11 quad_perm:[1,1,3,3] row_mask:0xf bank_mask:0xf
    v_max3_f32 v8, v40, v41, v42
    v_max3_f32 v8, v8, v43, v249
    v_mov_b32 v9, v8
    s_nop 1
    v_permlane16_swap_b32 v8, v9
    s_nop 1
    v_max_f32 v8, v8, v9
    v_mov_b32 v9, v8
    s_nop 1
    v_permlane32_swap_b32 v8, v9
    s_nop 1
    v_max_f32 v8, v8, v9
    v_sub_f32 v11, v249, v8
    v_mul_f32 v11, s52, v11
    v_exp_f32 v11, v11
    v_mov_b32 v249, v8
    v_mul_f32 v10, s52, v8
    v_sub_f32 v10, 0, v10
    v_fma_f32 v40, v40, s52, v10
    v_fma_f32 v41, v41, s52, v10
    v_fma_f32 v42, v42, s52, v10
    v_fma_f32 v43, v43, s52, v10
    v_exp_f32 v40, v40
    v_exp_f32 v41, v41
    v_exp_f32 v42, v42
    v_exp_f32 v43, v43
    v_readlane_b32 s34, v11, 0
    v_readlane_b32 s35, v11, 4
    v_readlane_b32 s36, v11, 8
    v_readlane_b32 s37, v11, 12
    v_add_f32 v12, v40, v41
    v_add_f32 v13, v42, v43
    v_add_f32 v12, v12, v13
    v_mov_b32 v13, v12
    s_nop 1
    v_permlane16_swap_b32 v12, v13
    s_nop 1
    v_add_f32 v12, v12, v13
    v_mov_b32 v13, v12
    s_nop 1
    v_permlane32_swap_b32 v12, v13
    s_nop 1
    v_add_f32 v12, v12, v13
    v_fma_f32 v252, v252, v11, v12
    v_mov_b32 v13, s34
    v_mov_b32 v14, s35
    v_cndmask_b32 v13, v13, v14, s[58:59]
    v_mov_b32 v14, s36
    v_cndmask_b32 v13, v13, v14, s[60:61]
    v_mov_b32 v14, s37
    v_cndmask_b32 v13, v13, v14, s[62:63]
    v_mul_f32 v32, v32, v13
    v_mul_f32 v33, v33, v13
    v_mul_f32 v34, v34, v13
    v_mul_f32 v35, v35, v13
    v_mul_f32 v36, v36, v13
    v_mul_f32 v37, v37, v13
    v_mul_f32 v38, v38, v13
    v_mul_f32 v39, v39, v13
    v_cvt_pk_bf16_f32 v9, v40, v40
    v_and_b32 v8, v9, v4
    v_and_b32 v9, v9, v5
    v_cvt_pk_bf16_f32 v11, v41, v41
    v_and_b32 v10, v11, v4
    v_and_b32 v11, v11, v5
    v_mfma_f32_16x16x16_bf16 v[32:35], v[8:9], v[152:153], v[32:35]
    v_mfma_f32_16x16x16_bf16 v[36:39], v[8:9], v[154:155], v[36:39]
    v_cvt_pk_bf16_f32 v13, v42, v42
    v_and_b32 v12, v13, v4
    v_and_b32 v13, v13, v5
    v_mfma_f32_16x16x16_bf16 v[32:35], v[10:11], v[156:157], v[32:35]
    v_mfma_f32_16x16x16_bf16 v[36:39], v[10:11], v[158:159], v[36:39]
    v_cvt_pk_bf16_f32 v15, v43, v43
    v_and_b32 v14, v15, v4
    v_and_b32 v15, v15, v5
    v_mfma_f32_16x16x16_bf16 v[32:35], v[12:13], v[160:161], v[32:35]
    v_mfma_f32_16x16x16_bf16 v[36:39], v[12:13], v[162:163], v[36:39]
    s_nop 1
    v_mfma_f32_16x16x16_bf16 v[32:35], v[14:15], v[164:165], v[32:35]
    v_mfma_f32_16x16x16_bf16 v[36:39], v[14:15], v[166:167], v[36:39]
    s_branch L_DDONE
L_DLAST_YX:
    v_mfma_f32_16x16x32_bf16 v[40:43], v[136:139], v[16:19], 0
    v_mfma_f32_16x16x32_bf16 v[24:27], v[144:147], v[16:19], 0
    v_mfma_f32_16x16x32_bf16 v[40:43], v[140:143], v[20:23], v[40:43]
    v_mfma_f32_16x16x32_bf16 v[24:27], v[148:151], v[20:23], v[24:27]
    s_nop 7
    s_nop 7
    v_permlane32_swap_b32 v40, v24
    v_permlane32_swap_b32 v41, v25
    v_permlane32_swap_b32 v42, v26
    v_permlane32_swap_b32 v43, v27
    s_nop 1
    v_mov_b32 v8, v40 quad_perm:[0,0,2,2] row_mask:0xf bank_mask:0xf
    v_mov_b32 v9, v41 quad_perm:[0,0,2,2] row_mask:0xf bank_mask:0xf
    v_mov_b32 v10, v42 quad_perm:[0,0,2,2] row_mask:0xf bank_mask:0xf
    v_mov_b32 v11, v43 quad_perm:[0,0,2,2] row_mask:0xf bank_mask:0xf
    v_add_f32 v40, v24, v8 quad_perm:[1,1,3,3] row_mask:0xf bank_mask:0xf
    v_add_f32 v41, v25, v9 quad_perm:[1,1,3,3] row_mask:0xf bank_mask:0xf
    v_add_f32 v42, v26, v10 quad_perm:[1,1,3,3] row_mask:0xf bank_mask:0xf
    v_add_f32 v43, v27, v11 quad_perm:[1,1,3,3] row_mask:0xf bank_mask:0xf
    v_max3_f32 v8, v40, v41, v42
    v_max3_f32 v8, v8, v43, v249
    v_mov_b32 v9, v8
    s_nop 1
    v_permlane16_swap_b32 v8, v9
    s_nop 1
    v_max_f32 v8, v8, v9
    v_mov_b32 v9, v8
    s_nop 1
    v_permlane32_swap_b32 v8, v9
    s_nop 1
    v_max_f32 v8, v8, v9
    v_sub_f32 v11, v249, v8
    v_mul_f32 v11, s52, v11
    v_exp_f32 v11, v11
    v_mov_b32 v249, v8
    v_mul_f32 v10, s52, v8
    v_sub_f32 v10, 0, v10
    v_fma_f32 v40, v40, s52, v10
    v_fma_f32 v41, v41, s52, v10
    v_fma_f32 v42, v42, s52, v10
    v_fma_f32 v43, v43, s52, v10
    v_exp_f32 v40, v40
    v_exp_f32 v41, v41
    v_exp_f32 v42, v42
    v_exp_f32 v43, v43
    v_readlane_b32 s34, v11, 0
    v_readlane_b32 s35, v11, 4
    v_readlane_b32 s36, v11, 8
    v_readlane_b32 s37, v11, 12
    v_add_f32 v12, v40, v41
    v_add_f32 v13, v42, v43
    v_add_f32 v12, v12, v13
    v_mov_b32 v13, v12
    s_nop 1
    v_permlane16_swap_b32 v12, v13
    s_nop 1
    v_add_f32 v12, v12, v13
    v_mov_b32 v13, v12
    s_nop 1
    v_permlane32_swap_b32 v12, v13
    s_nop 1
    v_add_f32 v12, v12, v13
    v_fma_f32 v252, v252, v11, v12
    v_mov_b32 v13, s34
    v_mov_b32 v14, s35
    v_cndmask_b32 v13, v13, v14, s[58:59]
    v_mov_b32 v14, s36
    v_cndmask_b32 v13, v13, v14, s[60:61]
    v_mov_b32 v14, s37
    v_cndmask_b32 v13, v13, v14, s[62:63]
    v_mul_f32 v32, v32, v13
    v_mul_f32 v33, v33, v13
    v_mul_f32 v34, v34, v13
    v_mul_f32 v35, v35, v13
    v_mul_f32 v36, v36, v13
    v_mul_f32 v37, v37, v13
    v_mul_f32 v38, v38, v13
    v_mul_f32 v39, v39, v13
    v_cvt_pk_bf16_f32 v9, v40, v40
    v_and_b32 v8, v9, v4
    v_and_b32 v9, v9, v5
    v_cvt_pk_bf16_f32 v11, v41, v41
    v_and_b32 v10, v11, v4
    v_and_b32 v11, v11, v5
    v_mfma_f32_16x16x16_bf16 v[32:35], v[8:9], v[152:153], v[32:35]
    v_mfma_f32_16x16x16_bf16 v[36:39], v[8:9], v[154:155], v[36:39]
    v_cvt_pk_bf16_f32 v13, v42, v42
    v_and_b32 v12, v13, v4
    v_and_b32 v13, v13, v5
    v_mfma_f32_16x16x16_bf16 v[32:35], v[10:11], v[156:157], v[32:35]
    v_mfma_f32_16x16x16_bf16 v[36:39], v[10:11], v[158:159], v[36:39]
    v_cvt_pk_bf16_f32 v15, v43, v43
    v_and_b32 v14, v15, v4
    v_and_b32 v15, v15, v5
    v_mfma_f32_16x16x16_bf16 v[32:35], v[12:13], v[160:161], v[32:35]
    v_mfma_f32_16x16x16_bf16 v[36:39], v[12:13], v[162:163], v[36:39]
    s_nop 1
    v_mfma_f32_16x16x16_bf16 v[32:35], v[14:15], v[164:165], v[32:35]
    v_mfma_f32_16x16x16_bf16 v[36:39], v[14:15], v[166:167], v[36:39]
L_DLAST_X:
    s_waitcnt vmcnt(0)
    v_mfma_f32_16x16x32_bf16 v[40:43], v[104:107], v[16:19], 0
    v_mfma_f32_16x16x32_bf16 v[24:27], v[112:115], v[16:19], 0
    v_mfma_f32_16x16x32_bf16 v[40:43], v[108:111], v[20:23], v[40:43]
    v_mfma_f32_16x16x32_bf16 v[24:27], v[116:119], v[20:23], v[24:27]
    s_nop 7
    s_nop 7
    v_permlane32_swap_b32 v40, v24
    v_permlane32_swap_b32 v41, v25
    v_permlane32_swap_b32 v42, v26
    v_permlane32_swap_b32 v43, v27
    s_nop 1
    v_mov_b32 v8, v40 quad_perm:[0,0,2,2] row_mask:0xf bank_mask:0xf
    v_mov_b32 v9, v41 quad_perm:[0,0,2,2] row_mask:0xf bank_mask:0xf
    v_mov_b32 v10, v42 quad_perm:[0,0,2,2] row_mask:0xf bank_mask:0xf
    v_mov_b32 v11, v43 quad_perm:[0,0,2,2] row_mask:0xf bank_mask:0xf
    v_add_f32 v40, v24, v8 quad_perm:[1,1,3,3] row_mask:0xf bank_mask:0xf
    v_add_f32 v41, v25, v9 quad_perm:[1,1,3,3] row_mask:0xf bank_mask:0xf
    v_add_f32 v42, v26, v10 quad_perm:[1,1,3,3] row_mask:0xf bank_mask:0xf
    v_add_f32 v43, v27, v11 quad_perm:[1,1,3,3] row_mask:0xf bank_mask:0xf
    v_max3_f32 v8, v40, v41, v42
    v_max3_f32 v8, v8, v43, v249
    v_mov_b32 v9, v8
    s_nop 1
    v_permlane16_swap_b32 v8, v9
    s_nop 1
    v_max_f32 v8, v8, v9
    v_mov_b32 v9, v8
    s_nop 1
    v_permlane32_swap_b32 v8, v9
    s_nop 1
    v_max_f32 v8, v8, v9
    v_sub_f32 v11, v249, v8
    v_mul_f32 v11, s52, v11
    v_exp_f32 v11, v11
    v_mov_b32 v249, v8
    v_mul_f32 v10, s52, v8
    v_sub_f32 v10, 0, v10
    v_fma_f32 v40, v40, s52, v10
    v_fma_f32 v41, v41, s52, v10
    v_fma_f32 v42, v42, s52, v10
    v_fma_f32 v43, v43, s52, v10
    v_exp_f32 v40, v40
    v_exp_f32 v41, v41
    v_exp_f32 v42, v42
    v_exp_f32 v43, v43
    v_readlane_b32 s34, v11, 0
    v_readlane_b32 s35, v11, 4
    v_readlane_b32 s36, v11, 8
    v_readlane_b32 s37, v11, 12
    v_add_f32 v12, v40, v41
    v_add_f32 v13, v42, v43
    v_add_f32 v12, v12, v13
    v_mov_b32 v13, v12
    s_nop 1
    v_permlane16_swap_b32 v12, v13
    s_nop 1
    v_add_f32 v12, v12, v13
    v_mov_b32 v13, v12
    s_nop 1
    v_permlane32_swap_b32 v12, v13
    s_nop 1
    v_add_f32 v12, v12, v13
    v_fma_f32 v252, v252, v11, v12
    v_mov_b32 v13, s34
    v_mov_b32 v14, s35
    v_cndmask_b32 v13, v13, v14, s[58:59]
    v_mov_b32 v14, s36
    v_cndmask_b32 v13, v13, v14, s[60:61]
    v_mov_b32 v14, s37
    v_cndmask_b32 v13, v13, v14, s[62:63]
    v_mul_f32 v32, v32, v13
    v_mul_f32 v33, v33, v13
    v_mul_f32 v34, v34, v13
    v_mul_f32 v35, v35, v13
    v_mul_f32 v36, v36, v13
    v_mul_f32 v37, v37, v13
    v_mul_f32 v38, v38, v13
    v_mul_f32 v39, v39, v13
    v_cvt_pk_bf16_f32 v9, v40, v40
    v_and_b32 v8, v9, v4
    v_and_b32 v9, v9, v5
    v_cvt_pk_bf16_f32 v11, v41, v41
    v_and_b32 v10, v11, v4
    v_and_b32 v11, v11, v5
    v_mfma_f32_16x16x16_bf16 v[32:35], v[8:9], v[120:121], v[32:35]
    v_mfma_f32_16x16x16_bf16 v[36:39], v[8:9], v[122:123], v[36:39]
    v_cvt_pk_bf16_f32 v13, v42, v42
    v_and_b32 v12, v13, v4
    v_and_b32 v13, v13, v5
    v_mfma_f32_16x16x16_bf16 v[32:35], v[10:11], v[124:125], v[32:35]
    v_mfma_f32_16x16x16_bf16 v[36:39], v[10:11], v[126:127], v[36:39]
    v_cvt_pk_bf16_f32 v15, v43, v43
    v_and_b32 v14, v15, v4
    v_and_b32 v15, v15, v5
    v_mfma_f32_16x16x16_bf16 v[32:35], v[12:13], v[128:129], v[32:35]
    v_mfma_f32_16x16x16_bf16 v[36:39], v[12:13], v[130:131], v[36:39]
    s_nop 1
    v_mfma_f32_16x16x16_bf16 v[32:35], v[14:15], v[132:133], v[32:35]
    v_mfma_f32_16x16x16_bf16 v[36:39], v[14:15], v[134:135], v[36:39]
L_DDONE:
    s_bfe_u32 s60, s2, 0x40003
    s_nop 7
L_TAIL:
    v_mov_b32 v8, v249
    v_mov_b32 v9, v252
    v_bfe_u32 v10, v1, 2, 2
    v_lshlrev_b32 v10, 6, v10
    s_lshl_b32 s50, s3, 3
    v_add_u32 v10, s50, v10
    v_and_b32 v11, 0x33, v1
    v_cmp_eq_u32 vcc, 0, v11
    s_and_saveexec_b64 s[56:57], vcc
    ds_write_b64 v10, v[8:9] offset:28672
    s_mov_b64 exec, s[56:57]
    v_lshrrev_b32 v10, 4, v1
    v_lshlrev_b32 v10, 9, v10
    v_and_b32 v11, 15, v1
    v_lshl_add_u32 v10, v11, 5, v10
    s_lshl_b32 s50, s3, 11
    v_add_u32 v10, s50, v10
    s_nop 7
    ds_write_b128 v10, v[32:35] offset:12288
    ds_write_b128 v10, v[36:39] offset:12304
    s_cmp_lg_u32 s3, 0
    s_cbranch_scc1 L_FC_OK
    s_mov_b32 s54, 262144
L_FC:
    s_waitcnt vmcnt(0)
    s_mov_b32 s53, 0x02020202
    v_and_b32 v253, s53, v253
    v_cmp_ne_u32 vcc, s53, v253
    s_cbranch_vccz L_FC_OK
    s_sub_u32 s54, s54, 1
    s_cmp_eq_u32 s54, 0
    s_cbranch_scc1 L_FC_OK
    s_sleep 1
    buffer_load_dword v253, v248, s[40:43], 0 offen sc0 sc1
    s_branch L_FC
L_FC_OK:
    s_waitcnt lgkmcnt(0)
    s_barrier
    v_lshlrev_b32 v10, 2, v0
    ds_read_b32 v16, v10 offset:12288
    ds_read_b32 v17, v10 offset:14336
    ds_read_b32 v18, v10 offset:16384
    ds_read_b32 v19, v10 offset:18432
    ds_read_b32 v20, v10 offset:20480
    ds_read_b32 v21, v10 offset:22528
    ds_read_b32 v22, v10 offset:24576
    ds_read_b32 v23, v10 offset:26624
    v_lshrrev_b32 v11, 7, v0
    v_lshlrev_b32 v11, 6, v11
    ds_read_b128 v[40:43], v11 offset:28672
    ds_read_b128 v[44:47], v11 offset:28688
    ds_read_b128 v[48:51], v11 offset:28704
    ds_read_b128 v[52:55], v11 offset:28720
    s_waitcnt lgkmcnt(0)
    v_max3_f32 v8, v40, v42, v44
    v_max3_f32 v8, v8, v46, v48
    v_max3_f32 v8, v8, v50, v52
    v_max_f32 v8, v8, v54
    v_sub_f32 v40, v40, v8
    v_mul_f32 v40, s52, v40
    v_sub_f32 v42, v42, v8
    v_mul_f32 v42, s52, v42
    v_sub_f32 v44, v44, v8
    v_mul_f32 v44, s52, v44
    v_sub_f32 v46, v46, v8
    v_mul_f32 v46, s52, v46
    v_sub_f32 v48, v48, v8
    v_mul_f32 v48, s52, v48
    v_sub_f32 v50, v50, v8
    v_mul_f32 v50, s52, v50
    v_sub_f32 v52, v52, v8
    v_mul_f32 v52, s52, v52
    v_sub_f32 v54, v54, v8
    v_mul_f32 v54, s52, v54
    v_exp_f32 v40, v40
    v_exp_f32 v42, v42
    v_exp_f32 v44, v44
    v_exp_f32 v46, v46
    v_exp_f32 v48, v48
    v_exp_f32 v50, v50
    v_exp_f32 v52, v52
    v_exp_f32 v54, v54
    s_nop 0
    v_mul_f32 v9, v40, v41
    v_mul_f32 v12, v40, v16
    v_fmac_f32 v9, v42, v43
    v_fmac_f32 v12, v42, v17
    v_fmac_f32 v9, v44, v45
    v_fmac_f32 v12, v44, v18
    v_fmac_f32 v9, v46, v47
    v_fmac_f32 v12, v46, v19
    v_fmac_f32 v9, v48, v49
    v_fmac_f32 v12, v48, v20
    v_fmac_f32 v9, v50, v51
    v_fmac_f32 v12, v50, v21
    v_fmac_f32 v9, v52, v53
    v_fmac_f32 v12, v52, v22
    v_fmac_f32 v9, v54, v55
    v_fmac_f32 v12, v54, v23
    v_min_u32 v8, 0xfffffffe, v8
    v_min_u32 v9, 0xfffffffe, v9
    v_min_u32 v12, 0xfffffffe, v12
    s_mov_b32 s50, s60
    s_lshl_b32 s50, s50, 16
    s_lshl_b32 s53, s6, 8
    s_add_u32 s50, s50, s53
    v_lshrrev_b32 v10, 5, v0
    v_lshlrev_b32 v10, 12, v10
    v_and_b32 v255, 31, v0
    v_lshl_add_u32 v10, v255, 2, v10
    v_add_u32 v10, s50, v10
    buffer_store_dword v12, v10, s[44:47], 0 offen sc0 sc1
    v_cmp_eq_u32 vcc, 0, v255
    s_and_saveexec_b64 s[56:57], vcc
    buffer_store_dwordx2 v[8:9], v10, s[44:47], 0 offen offset:128 sc0 sc1
    s_mov_b64 exec, s[56:57]
    s_cmp_lg_u32 s3, 0
    s_cbranch_scc1 L_BAR4
    s_mov_b32 s50, s60
    s_lshl_b32 s50, s50, 16
    s_lshl_b32 s53, s6, 12
    s_add_u32 s50, s50, s53
    v_lshrrev_b32 v10, 2, v1
    v_lshlrev_b32 v10, 8, v10
    v_and_b32 v11, 3, v1
    v_lshlrev_b32 v12, 5, v11
    v_add_u32 v12, v12, v10
    s_mov_b32 s54, 262144
L_P1:
    buffer_load_dwordx4 v[16:19], v12, s[44:47], s50 offen sc0 sc1
    buffer_load_dwordx4 v[20:23], v12, s[44:47], s50 offen offset:16 sc0 sc1
    buffer_load_dwordx2 v[24:25], v10, s[44:47], s50 offen offset:128 sc0 sc1
    s_waitcnt vmcnt(0)
    v_max3_u32 v8, v16, v17, v18
    v_max3_u32 v8, v8, v19, v20
    v_max3_u32 v8, v8, v21, v22
    v_max3_u32 v8, v8, v23, v24
    v_max_u32 v8, v8, v25
    v_cmp_eq_u32 vcc, -1, v8
    s_cbranch_vccz L_P1_OK
    s_sub_u32 s54, s54, 1
    s_cmp_eq_u32 s54, 0
    s_cbranch_scc1 L_P1_OK
    s_sleep 1
    s_branch L_P1
L_P1_OK:
    v_mov_b32 v8, v24
    s_nop 1
    v_max_f32 v8, v8, v8 row_ror:4 row_mask:0xf bank_mask:0xf
    s_nop 1
    v_max_f32 v8, v8, v8 row_ror:8 row_mask:0xf bank_mask:0xf
    v_mov_b32 v9, v8
    s_nop 1
    v_permlane16_swap_b32 v8, v9
    s_nop 1
    v_max_f32 v8, v8, v9
    v_mov_b32 v9, v8
    s_nop 1
    v_permlane32_swap_b32 v8, v9
    s_nop 1
    v_max_f32 v8, v8, v9
    v_sub_f32 v9, v24, v8
    v_mul_f32 v9, s52, v9
    v_exp_f32 v9, v9
    s_nop 0
    v_mul_f32 v25, v25, v9
    v_mul_f32 v16, v16, v9
    v_mul_f32 v17, v17, v9
    v_mul_f32 v18, v18, v9
    v_mul_f32 v19, v19, v9
    v_mul_f32 v20, v20, v9
    v_mul_f32 v21, v21, v9
    v_mul_f32 v22, v22, v9
    v_mul_f32 v23, v23, v9
    s_nop 1
    v_add_f32 v16, v16, v16 row_ror:4 row_mask:0xf bank_mask:0xf
    v_add_f32 v17, v17, v17 row_ror:4 row_mask:0xf bank_mask:0xf
    v_add_f32 v18, v18, v18 row_ror:4 row_mask:0xf bank_mask:0xf
    v_add_f32 v19, v19, v19 row_ror:4 row_mask:0xf bank_mask:0xf
    v_add_f32 v20, v20, v20 row_ror:4 row_mask:0xf bank_mask:0xf
    v_add_f32 v21, v21, v21 row_ror:4 row_mask:0xf bank_mask:0xf
    v_add_f32 v22, v22, v22 row_ror:4 row_mask:0xf bank_mask:0xf
    v_add_f32 v23, v23, v23 row_ror:4 row_mask:0xf bank_mask:0xf
    v_add_f32 v25, v25, v25 row_ror:4 row_mask:0xf bank_mask:0xf
    s_nop 1
    v_add_f32 v16, v16, v16 row_ror:8 row_mask:0xf bank_mask:0xf
    v_add_f32 v17, v17, v17 row_ror:8 row_mask:0xf bank_mask:0xf
    v_add_f32 v18, v18, v18 row_ror:8 row_mask:0xf bank_mask:0xf
    v_add_f32 v19, v19, v19 row_ror:8 row_mask:0xf bank_mask:0xf
    v_add_f32 v20, v20, v20 row_ror:8 row_mask:0xf bank_mask:0xf
    v_add_f32 v21, v21, v21 row_ror:8 row_mask:0xf bank_mask:0xf
    v_add_f32 v22, v22, v22 row_ror:8 row_mask:0xf bank_mask:0xf
    v_add_f32 v23, v23, v23 row_ror:8 row_mask:0xf bank_mask:0xf
    v_add_f32 v25, v25, v25 row_ror:8 row_mask:0xf bank_mask:0xf
    v_mov_b32 v40, v16
    v_mov_b32 v41, v17
    v_mov_b32 v42, v18
    v_mov_b32 v43, v19
    v_mov_b32 v44, v20
    v_mov_b32 v45, v21
    v_mov_b32 v46, v22
    v_mov_b32 v47, v23
    v_mov_b32 v48, v25
    s_nop 1
    v_permlane16_swap_b32 v16, v40
    v_permlane16_swap_b32 v17, v41
    v_permlane16_swap_b32 v18, v42
    v_permlane16_swap_b32 v19, v43
    v_permlane16_swap_b32 v20, v44
    v_permlane16_swap_b32 v21, v45
    v_permlane16_swap_b32 v22, v46
    v_permlane16_swap_b32 v23, v47
    v_permlane16_swap_b32 v25, v48
    s_nop 1
    v_add_f32 v16, v16, v40
    v_add_f32 v17, v17, v41
    v_add_f32 v18, v18, v42
    v_add_f32 v19, v19, v43
    v_add_f32 v20, v20, v44
    v_add_f32 v21, v21, v45
    v_add_f32 v22, v22, v46
    v_add_f32 v23, v23, v47
    v_add_f32 v25, v25, v48
    v_mov_b32 v40, v16
    v_mov_b32 v41, v17
    v_mov_b32 v42, v18
    v_mov_b32 v43, v19
    v_mov_b32 v44, v20
    v_mov_b32 v45, v21
    v_mov_b32 v46, v22
    v_mov_b32 v47, v23
    v_mov_b32 v48, v25
    s_nop 1
    v_permlane32_swap_b32 v16, v40
    v_permlane32_swap_b32 v17, v41
    v_permlane32_swap_b32 v18, v42
    v_permlane32_swap_b32 v19, v43
    v_permlane32_swap_b32 v20, v44
    v_permlane32_swap_b32 v21, v45
    v_permlane32_swap_b32 v22, v46
    v_permlane32_swap_b32 v23, v47
    v_permlane32_swap_b32 v25, v48
    s_nop 1
    v_add_f32 v16, v16, v40
    v_add_f32 v17, v17, v41
    v_add_f32 v18, v18, v42
    v_add_f32 v19, v19, v43
    v_add_f32 v20, v20, v44
    v_add_f32 v21, v21, v45
    v_add_f32 v22, v22, v46
    v_add_f32 v23, v23, v47
    v_add_f32 v25, v25, v48
    v_rcp_f32 v25, v25
    s_nop 0
    v_mul_f32 v16, v16, v25
    v_mul_f32 v17, v17, v25
    v_mul_f32 v18, v18, v25
    v_mul_f32 v19, v19, v25
    v_mul_f32 v20, v20, v25
    v_mul_f32 v21, v21, v25
    v_mul_f32 v22, v22, v25
    v_mul_f32 v23, v23, v25
    v_cvt_pk_bf16_f32 v26, v16, v17
    v_cvt_pk_bf16_f32 v27, v18, v19
    v_cvt_pk_bf16_f32 v28, v20, v21
    v_cvt_pk_bf16_f32 v29, v22, v23
    v_and_b32 v11, 3, v1
    v_lshlrev_b32 v11, 4, v11
    s_mov_b64 exec, 15
    ds_write_b128 v11, v[26:29] offset:28928
    s_mov_b64 exec, -1
    s_waitcnt lgkmcnt(0)
L_BAR4:
    s_barrier
    v_mov_b32 v10, 0
    ds_read_b128 v[16:19], v10 offset:28928
    ds_read_b128 v[20:23], v10 offset:28944
    ds_read_b128 v[24:27], v10 offset:28960
    ds_read_b128 v[28:31], v10 offset:28976
    s_waitcnt lgkmcnt(0)
    v_mov_b32 v8, 0
    v_mov_b32 v9, 0
    v_dot2_f32_bf16 v8, v232, v16, v8
    v_dot2_f32_bf16 v9, v233, v17, v9
    v_dot2_f32_bf16 v8, v234, v18, v8
    v_dot2_f32_bf16 v9, v235, v19, v9
    v_dot2_f32_bf16 v8, v236, v20, v8
    v_dot2_f32_bf16 v9, v237, v21, v9
    v_dot2_f32_bf16 v8, v238, v22, v8
    v_dot2_f32_bf16 v9, v239, v23, v9
    v_dot2_f32_bf16 v8, v240, v24, v8
    v_dot2_f32_bf16 v9, v241, v25, v9
    v_dot2_f32_bf16 v8, v242, v26, v8
    v_dot2_f32_bf16 v9, v243, v27, v9
    v_dot2_f32_bf16 v8, v244, v28, v8
    v_dot2_f32_bf16 v9, v245, v29, v9
    v_dot2_f32_bf16 v8, v246, v30, v8
    v_dot2_f32_bf16 v9, v247, v31, v9
    s_nop 2
    v_add_f32 v8, v8, v9
    v_min_u32 v8, 0xfffffffe, v8
    s_lshl_b32 s50, s5, 18
    s_lshl_b32 s53, s51, 4
    s_add_u32 s50, s50, s53
    s_add_u32 s50, s50, 0x100000
    v_lshrrev_b32 v10, 2, v0
    v_lshlrev_b32 v10, 11, v10
    v_and_b32 v255, 3, v0
    v_lshl_add_u32 v10, v255, 2, v10
    v_add_u32 v10, s50, v10
    buffer_store_dword v8, v10, s[44:47], 0 offen sc0 sc1
    s_cmp_lg_u32 s3, 0
    s_cbranch_scc1 L_END
    s_lshl_b32 s50, s5, 18
    s_lshl_b32 s53, s51, 11
    s_add_u32 s50, s50, s53
    s_add_u32 s53, s50, 0x180000
    s_add_u32 s50, s50, 0x100000
    v_lshlrev_b32 v10, 4, v1
    v_mov_b32 v24, 0
    v_mov_b32 v25, 0
    v_mov_b32 v26, 0
    v_mov_b32 v27, 0
    v_mov_b32 v28, 0
    v_mov_b32 v29, 0
    v_mov_b32 v30, 0
    v_mov_b32 v31, 0
    buffer_load_dwordx4 v[24:27], v10, s[44:47], s53 offen sc0 sc1
    s_mov_b32 exec_hi, 0xffff
    buffer_load_dwordx4 v[28:31], v10, s[44:47], s53 offen offset:1024 sc0 sc1
    s_mov_b64 exec, -1
    s_mov_b32 s54, 262144
L_P2:
    buffer_load_dwordx4 v[16:19], v10, s[44:47], s50 offen sc0 sc1
    buffer_load_dwordx4 v[20:23], v10, s[44:47], s50 offen offset:1024 sc0 sc1
    s_waitcnt vmcnt(0)
    v_max3_u32 v8, v16, v17, v18
    v_max3_u32 v8, v8, v19, v20
    v_max3_u32 v8, v8, v21, v22
    v_max_u32 v8, v8, v23
    v_cmp_eq_u32 vcc, -1, v8
    s_cbranch_vccz L_P2_OK
    s_sub_u32 s54, s54, 1
    s_cmp_eq_u32 s54, 0
    s_cbranch_scc1 L_P2_OK
    s_sleep 1
    s_branch L_P2
L_P2_OK:
    v_add_f32 v16, v16, v20
    v_add_f32 v24, v24, v28
    v_add_f32 v17, v17, v21
    v_add_f32 v25, v25, v29
    v_add_f32 v18, v18, v22
    v_add_f32 v26, v26, v30
    v_add_f32 v19, v19, v23
    v_add_f32 v27, v27, v31
    s_nop 1
    v_add_f32 v16, v16, v16 quad_perm:[1,0,3,2] row_mask:0xf bank_mask:0xf
    v_add_f32 v17, v17, v17 quad_perm:[1,0,3,2] row_mask:0xf bank_mask:0xf
    v_add_f32 v18, v18, v18 quad_perm:[1,0,3,2] row_mask:0xf bank_mask:0xf
    v_add_f32 v19, v19, v19 quad_perm:[1,0,3,2] row_mask:0xf bank_mask:0xf
    v_add_f32 v24, v24, v24 quad_perm:[1,0,3,2] row_mask:0xf bank_mask:0xf
    v_add_f32 v25, v25, v25 quad_perm:[1,0,3,2] row_mask:0xf bank_mask:0xf
    v_add_f32 v26, v26, v26 quad_perm:[1,0,3,2] row_mask:0xf bank_mask:0xf
    v_add_f32 v27, v27, v27 quad_perm:[1,0,3,2] row_mask:0xf bank_mask:0xf
    s_nop 1
    v_add_f32 v16, v16, v16 quad_perm:[2,3,0,1] row_mask:0xf bank_mask:0xf
    v_add_f32 v17, v17, v17 quad_perm:[2,3,0,1] row_mask:0xf bank_mask:0xf
    v_add_f32 v18, v18, v18 quad_perm:[2,3,0,1] row_mask:0xf bank_mask:0xf
    v_add_f32 v19, v19, v19 quad_perm:[2,3,0,1] row_mask:0xf bank_mask:0xf
    v_add_f32 v24, v24, v24 quad_perm:[2,3,0,1] row_mask:0xf bank_mask:0xf
    v_add_f32 v25, v25, v25 quad_perm:[2,3,0,1] row_mask:0xf bank_mask:0xf
    v_add_f32 v26, v26, v26 quad_perm:[2,3,0,1] row_mask:0xf bank_mask:0xf
    v_add_f32 v27, v27, v27 quad_perm:[2,3,0,1] row_mask:0xf bank_mask:0xf
    s_nop 1
    v_add_f32 v16, v16, v16 row_half_mirror row_mask:0xf bank_mask:0xf
    v_add_f32 v17, v17, v17 row_half_mirror row_mask:0xf bank_mask:0xf
    v_add_f32 v18, v18, v18 row_half_mirror row_mask:0xf bank_mask:0xf
    v_add_f32 v19, v19, v19 row_half_mirror row_mask:0xf bank_mask:0xf
    v_add_f32 v24, v24, v24 row_half_mirror row_mask:0xf bank_mask:0xf
    v_add_f32 v25, v25, v25 row_half_mirror row_mask:0xf bank_mask:0xf
    v_add_f32 v26, v26, v26 row_half_mirror row_mask:0xf bank_mask:0xf
    v_add_f32 v27, v27, v27 row_half_mirror row_mask:0xf bank_mask:0xf
    s_nop 1
    v_add_f32 v16, v16, v16 row_mirror row_mask:0xf bank_mask:0xf
    v_add_f32 v17, v17, v17 row_mirror row_mask:0xf bank_mask:0xf
    v_add_f32 v18, v18, v18 row_mirror row_mask:0xf bank_mask:0xf
    v_add_f32 v19, v19, v19 row_mirror row_mask:0xf bank_mask:0xf
    v_add_f32 v24, v24, v24 row_mirror row_mask:0xf bank_mask:0xf
    v_add_f32 v25, v25, v25 row_mirror row_mask:0xf bank_mask:0xf
    v_add_f32 v26, v26, v26 row_mirror row_mask:0xf bank_mask:0xf
    v_add_f32 v27, v27, v27 row_mirror row_mask:0xf bank_mask:0xf
    v_mov_b32 v40, v16
    v_mov_b32 v41, v17
    v_mov_b32 v42, v18
    v_mov_b32 v43, v19
    v_mov_b32 v44, v24
    v_mov_b32 v45, v25
    v_mov_b32 v46, v26
    v_mov_b32 v47, v27
    s_nop 1
    v_permlane16_swap_b32 v16, v40
    v_permlane16_swap_b32 v17, v41
    v_permlane16_swap_b32 v18, v42
    v_permlane16_swap_b32 v19, v43
    v_permlane16_swap_b32 v24, v44
    v_permlane16_swap_b32 v25, v45
    v_permlane16_swap_b32 v26, v46
    v_permlane16_swap_b32 v27, v47
    s_nop 1
    v_add_f32 v16, v16, v40
    v_add_f32 v17, v17, v41
    v_add_f32 v18, v18, v42
    v_add_f32 v19, v19, v43
    v_add_f32 v24, v24, v44
    v_add_f32 v25, v25, v45
    v_add_f32 v26, v26, v46
    v_add_f32 v27, v27, v47
    v_mov_b32 v40, v16
    v_mov_b32 v41, v17
    v_mov_b32 v42, v18
    v_mov_b32 v43, v19
    v_mov_b32 v44, v24
    v_mov_b32 v45, v25
    v_mov_b32 v46, v26
    v_mov_b32 v47, v27
    s_nop 1
    v_permlane32_swap_b32 v16, v40
    v_permlane32_swap_b32 v17, v41
    v_permlane32_swap_b32 v18, v42
    v_permlane32_swap_b32 v19, v43
    v_permlane32_swap_b32 v24, v44
    v_permlane32_swap_b32 v25, v45
    v_permlane32_swap_b32 v26, v46
    v_permlane32_swap_b32 v27, v47
    s_nop 1
    v_add_f32 v16, v16, v40
    v_add_f32 v17, v17, v41
    v_add_f32 v18, v18, v42
    v_add_f32 v19, v19, v43
    v_add_f32 v24, v24, v44
    v_add_f32 v25, v25, v45
    v_add_f32 v26, v26, v46
    v_add_f32 v27, v27, v47
    v_cvt_pk_bf16_f32 v16, v16, v16
    v_and_b32 v16, 0xffff0000, v16
    v_cvt_pk_bf16_f32 v24, v24, v24
    v_and_b32 v24, 0xffff0000, v24
    v_cvt_pk_bf16_f32 v17, v17, v17
    v_and_b32 v17, 0xffff0000, v17
    v_cvt_pk_bf16_f32 v25, v25, v25
    v_and_b32 v25, 0xffff0000, v25
    v_cvt_pk_bf16_f32 v18, v18, v18
    v_and_b32 v18, 0xffff0000, v18
    v_cvt_pk_bf16_f32 v26, v26, v26
    v_and_b32 v26, 0xffff0000, v26
    v_cvt_pk_bf16_f32 v19, v19, v19
    v_and_b32 v19, 0xffff0000, v19
    v_cvt_pk_bf16_f32 v27, v27, v27
    v_and_b32 v27, 0xffff0000, v27
    v_mul_f32 v28, 0xbfb8aa3b, v24
    v_mul_f32 v29, 0xbfb8aa3b, v25
    v_mul_f32 v30, 0xbfb8aa3b, v26
    v_mul_f32 v31, 0xbfb8aa3b, v27
    v_exp_f32 v28, v28
    v_exp_f32 v29, v29
    v_exp_f32 v30, v30
    v_exp_f32 v31, v31
    s_nop 0
    v_add_f32 v28, 1.0, v28
    v_add_f32 v29, 1.0, v29
    v_add_f32 v30, 1.0, v30
    v_add_f32 v31, 1.0, v31
    v_rcp_f32 v28, v28
    v_rcp_f32 v29, v29
    v_rcp_f32 v30, v30
    v_rcp_f32 v31, v31
    s_nop 0
    v_mul_f32 v24, v24, v28
    v_cvt_pk_bf16_f32 v24, v24, v24
    v_and_b32 v24, 0xffff0000, v24
    v_mul_f32 v16, v16, v24
    v_cvt_pk_bf16_f32 v16, v16, v16
    v_and_b32 v16, 0xffff0000, v16
    v_mul_f32 v25, v25, v29
    v_cvt_pk_bf16_f32 v25, v25, v25
    v_and_b32 v25, 0xffff0000, v25
    v_mul_f32 v17, v17, v25
    v_cvt_pk_bf16_f32 v17, v17, v17
    v_and_b32 v17, 0xffff0000, v17
    v_mul_f32 v26, v26, v30
    v_cvt_pk_bf16_f32 v26, v26, v26
    v_and_b32 v26, 0xffff0000, v26
    v_mul_f32 v18, v18, v26
    v_cvt_pk_bf16_f32 v18, v18, v18
    v_and_b32 v18, 0xffff0000, v18
    v_mul_f32 v27, v27, v31
    v_cvt_pk_bf16_f32 v27, v27, v27
    v_and_b32 v27, 0xffff0000, v27
    v_mul_f32 v19, v19, v27
    v_cvt_pk_bf16_f32 v19, v19, v19
    v_and_b32 v19, 0xffff0000, v19
    v_lshlrev_b32 v20, 16, v250
    v_and_b32 v21, 0xffff0000, v250
    v_lshlrev_b32 v22, 16, v251
    v_and_b32 v23, 0xffff0000, v251
    v_add_f32 v16, v16, v20
    v_add_f32 v17, v17, v21
    v_add_f32 v18, v18, v22
    v_add_f32 v19, v19, v23
    v_cvt_pk_bf16_f32 v8, v16, v17
    v_cvt_pk_bf16_f32 v9, v18, v19
    v_mov_b32 v10, 0
    s_lshl_b32 s50, s5, 10
    s_lshl_b32 s53, s51, 3
    s_add_u32 s50, s50, s53
    s_mov_b64 exec, 1
    buffer_store_dwordx2 v[8:9], v10, s[36:39], s50 offen
L_END:
L_FIN:
s_endpgm
.section .rodata,"a"
.p2align 6
.amdhsa_kernel recurrent_scan__gqa_block_cached__dense_activation_relu__decode_kernel
  .amdhsa_next_free_vgpr 256
  .amdhsa_next_free_sgpr 102
  .amdhsa_accum_offset 256
  .amdhsa_group_segment_fixed_size 0
  .amdhsa_kernarg_size 88
  .amdhsa_user_sgpr_count 2
  .amdhsa_user_sgpr_kernarg_segment_ptr 1
  .amdhsa_system_sgpr_workgroup_id_x 1
.end_amdhsa_kernel
```
